```python
import torch

def _softmax(x, axis=-1):
    return torch.softmax(x, dim=axis)
def _gelu(x):
    return torch.nn.functional.gelu(x, approximate="tanh")
def _silu(x):
    return torch.nn.functional.silu(x)
def _sigmoid(x):
    return torch.sigmoid(x)
def _layernorm(x, axis=-1, eps=1e-5):
    m = x.mean(dim=axis, keepdim=True)
    v = x.var(dim=axis, keepdim=True, unbiased=False)
    return (x - m) / torch.sqrt(v + eps)
def _scatter_add(tgt, idx, src, axis=0):
    return tgt.clone().index_add_(axis, idx, src)
def _segment_sum(src, seg, n):
    out = torch.zeros((n,) + src.shape[1:], dtype=src.dtype)
    return out.index_add_(0, seg, src)
def _pad(x, pw):
    flat = tuple(v for pair in reversed(pw) for v in pair)
    return torch.nn.functional.pad(x, flat)

kernel_name = 'standalone__cheap_equivariant_egnn__graph'

def setup_inputs():

    _w = (lambda a: (lambda t: t.to(torch.bfloat16) if t.is_floating_point() else t)(torch.as_tensor(a)))
    N, deg, D, De = 10000, 16, 256, max(4, 1)
    E = N * deg
    return {
        "h": _w((lambda *s: torch.randn(*s, dtype=torch.bfloat16) * 0.2)(N, D)),
        "pos": _w((lambda *s: torch.randn(*s, dtype=torch.bfloat16) * 0.4)(N, 3)),
        "e_attr": _w((lambda *s: torch.randn(*s, dtype=torch.bfloat16) * 0.4)(E, De)),
        "src": _w((lambda lo, hi, *s: torch.randint(lo, hi, s))(0, N, E).to(torch.int64)),
        "dst": _w((lambda lo, hi, *s: torch.randint(lo, hi, s))(0, N, E).to(torch.int64)),
        "w_e": _w(0.1 * (lambda *s: torch.randn(*s, dtype=torch.bfloat16) * 0.4)(2 * D + 1 + De, D)),
        "w_x": _w(0.1 * (lambda *s: torch.randn(*s, dtype=torch.bfloat16) * 0.2)(D, 1)),
        "w_h": _w(0.1 * (lambda *s: torch.randn(*s, dtype=torch.bfloat16) * 0.2)(2 * D, D)),
    }

def reference(h, pos, e_attr, src, dst, w_e, w_x, w_h):
    N, D = h.shape[0], h.shape[1]
    diff = pos[dst] - pos[src]
    dist2 = torch.sum(diff * diff, axis=-1, keepdims=True)
    e_in = torch.concatenate([h[dst], h[src], dist2, e_attr], axis=-1)
    m_ij = _silu(e_in @ w_e)
    coord_scale = m_ij @ w_x
    pos_new = pos + _segment_sum(diff * coord_scale, dst, N)
    m_i = _segment_sum(m_ij, dst, N)
    h_new = h + _silu(torch.concatenate([h, m_i], axis=-1) @ w_h)
    return h_new, pos_new
```

```asm
; @launch grid=(250,1,1) block=(512,1,1) lds=163840
.amdgcn_target "amdgcn-amd-amdhsa--gfx950"
.text
.globl standalone__cheap_equivariant_egnn__graph_kernel
.p2align 8
.type standalone__cheap_equivariant_egnn__graph_kernel,@function
standalone__cheap_equivariant_egnn__graph_kernel:
    s_cmp_ge_u32 s2, 250
    s_cbranch_scc1 L_exit
    s_load_dwordx4 s[4:7], s[0:1], 0
    s_load_dwordx4 s[8:11], s[0:1], 16
    s_load_dwordx4 s[12:15], s[0:1], 32
    s_load_dwordx4 s[16:19], s[0:1], 48
    s_load_dwordx2 s[22:23], s[0:1], 64
    s_load_dwordx2 s[24:25], s[0:1], 72
    s_load_dwordx2 s[20:21], s[0:1], 80
    v_and_b32 v1, 63, v0
    v_lshrrev_b32 v2, 6, v0
    s_sub_u32 s56, s2, 0
    v_readfirstlane_b32 s3, v2
    s_lshr_b32 s53, s56, 3
    s_and_b32 s54, s56, 7
    s_mul_hi_u32 s55, s53, 0x55555556
    s_mul_i32 s52, s55, 3
    s_sub_u32 s57, s53, s52
    s_mul_i32 s58, s54, 7
    s_add_u32 s58, s58, s55
    s_cmp_lt_u32 s56, 168
    s_cbranch_scc1 1f
    s_sub_u32 s56, s56, 168
    s_mul_hi_u32 s58, s56, 0x55555556
    s_mul_i32 s52, s58, 3
    s_sub_u32 s57, s56, s52
    s_add_u32 s58, s58, 56
1:
    s_waitcnt lgkmcnt(0)
    s_cmp_gt_u32 s2, 189
    s_cbranch_scc1 L1_sort
    s_cmp_eq_u32 s2, 189
    s_cbranch_scc1 L1_pack
    s_cmp_eq_u32 s57, 1
    s_cbranch_scc1 L1_gemm_Q
    s_cmp_eq_u32 s57, 2
    s_cbranch_scc1 L1_gemm_R
L1_gemm_P:
    s_mov_b32 s28, s14
    s_mov_b32 s29, s15
    s_mov_b32 s30, 131072
    s_mov_b32 s31, 0x20000
    s_mov_b32 s32, s4
    s_mov_b32 s33, s5
    s_mov_b32 s34, 5120000
    s_mov_b32 s35, 0x20000
    v_lshrrev_b32 v2, 2, v1
    v_lshlrev_b32 v2, 9, v2
    v_and_b32 v3, 3, v1
    v_lshl_add_u32 v2, v3, 4, v2
    s_lshl_b32 s52, s3, 6
    v_add_u32 v2, s52, v2
    v_lshrrev_b32 v5, 5, v1
    s_lshl_b32 s52, s3, 2
    v_and_b32 v6, 31, v1
    v_add_u32 v7, s52, v5
    v_and_b32 v16, 15, v7
    v_xor_b32 v16, v16, v6
    v_lshlrev_b32 v16, 4, v16
    v_lshl_add_u32 v3, v7, 9, v16
    v_add_u32 v7, s52, v5
    v_add_u32 v7, 2, v7
    v_and_b32 v16, 15, v7
    v_xor_b32 v16, v16, v6
    v_lshlrev_b32 v16, 4, v16
    v_lshl_add_u32 v4, v7, 9, v16
    s_mul_i32 s59, s58, 81920
    s_lshl_b32 s60, s3, 11
    s_lshl_b32 s62, s3, 14
    s_setprio 3
    s_add_u32 m0, s60, 131072
    s_add_u32 s54, s59, 0
    buffer_load_dwordx4 v3, s[32:35], s54 offen lds
    s_add_u32 m0, s60, 132096
    s_add_u32 s54, s59, 0
    buffer_load_dwordx4 v4, s[32:35], s54 offen lds
    s_add_u32 m0, s62, 0
    s_mov_b32 s54, 0
    buffer_load_dwordx4 v2, s[28:31], s54 offen lds
    s_add_u32 m0, s62, 1024
    s_mov_b32 s54, 8192
    buffer_load_dwordx4 v2, s[28:31], s54 offen lds
    s_add_u32 m0, s62, 2048
    s_mov_b32 s54, 16384
    buffer_load_dwordx4 v2, s[28:31], s54 offen lds
    s_add_u32 m0, s62, 3072
    s_mov_b32 s54, 24576
    buffer_load_dwordx4 v2, s[28:31], s54 offen lds
    s_add_u32 m0, s62, 4096
    s_mov_b32 s54, 32768
    buffer_load_dwordx4 v2, s[28:31], s54 offen lds
    s_add_u32 m0, s62, 5120
    s_mov_b32 s54, 40960
    buffer_load_dwordx4 v2, s[28:31], s54 offen lds
    s_add_u32 m0, s62, 6144
    s_mov_b32 s54, 49152
    buffer_load_dwordx4 v2, s[28:31], s54 offen lds
    s_add_u32 m0, s62, 7168
    s_mov_b32 s54, 57344
    buffer_load_dwordx4 v2, s[28:31], s54 offen lds
    s_setprio 0
    s_add_u32 s36, s20, 5242880
    s_addc_u32 s37, s21, 0
    s_mov_b32 s38, 5120000
    s_mov_b32 s39, 0x20000
    v_lshrrev_b32 v5, 5, v1
    v_bfe_u32 v6, v1, 2, 2
    v_lshl_add_u32 v6, v5, 3, v6
    v_lshlrev_b32 v6, 6, v6
    v_bfe_u32 v7, v1, 4, 1
    v_and_b32 v16, 3, v1
    v_lshl_add_u32 v7, v7, 2, v16
    v_lshlrev_b32 v7, 3, v7
    v_add_u32 v5, v6, v7
    s_lshl_b32 s53, s3, 14
    v_add_u32 v5, s53, v5
    v_and_b32 v6, 31, v1
    v_lshrrev_b32 v7, 5, v1
    v_and_b32 v16, 15, v6
    v_xor_b32 v7, v7, v16
    v_lshlrev_b32 v6, 9, v6
    v_add_u32 v6, 0x20000, v6
    v_xor_b32 v16, 0, v7
    v_lshl_add_u32 v8, v16, 4, v6
    v_xor_b32 v16, 2, v7
    v_lshl_add_u32 v9, v16, 4, v6
    v_xor_b32 v16, 4, v7
    v_lshl_add_u32 v10, v16, 4, v6
    v_xor_b32 v16, 6, v7
    v_lshl_add_u32 v11, v16, 4, v6
    v_xor_b32 v16, 8, v7
    v_lshl_add_u32 v12, v16, 4, v6
    v_xor_b32 v16, 10, v7
    v_lshl_add_u32 v13, v16, 4, v6
    v_xor_b32 v16, 12, v7
    v_lshl_add_u32 v14, v16, 4, v6
    v_xor_b32 v16, 14, v7
    v_lshl_add_u32 v15, v16, 4, v6
    v_and_b32 v6, 31, v1
    v_lshrrev_b32 v7, 5, v1
    s_mul_i32 s61, s58, 81920
    s_lshl_b32 s52, s3, 9
    v_lshlrev_b32 v17, 4, v6
    v_lshl_add_u32 v17, v7, 12, v17
    v_add_u32 v17, s52, v17
    s_mov_b32 s56, 0xbfb8aa3b
    s_waitcnt vmcnt(8)
    s_barrier
    ds_read_b128 v[112:115], v8 offset:0
    ds_read_b128 v[116:119], v9 offset:0
    ds_read_b128 v[120:123], v10 offset:0
    ds_read_b128 v[124:127], v11 offset:0
    ds_read_b128 v[128:131], v12 offset:0
    ds_read_b128 v[132:135], v13 offset:0
    s_waitcnt vmcnt(7)
    ds_read_b64_tr_b16 v[48:49], v5 offset:0
    ds_read_b64_tr_b16 v[50:51], v5 offset:256
    s_waitcnt vmcnt(6)
    ds_read_b64_tr_b16 v[52:53], v5 offset:1024
    ds_read_b64_tr_b16 v[54:55], v5 offset:1280
    s_add_u32 m0, s62, 8192
    s_mov_b32 s54, 65536
    buffer_load_dwordx4 v2, s[28:31], s54 offen lds
    s_waitcnt vmcnt(6)
    ds_read_b64_tr_b16 v[56:57], v5 offset:2048
    ds_read_b64_tr_b16 v[58:59], v5 offset:2304
    s_waitcnt lgkmcnt(4)
    v_mfma_f32_32x32x16_bf16 v[152:167], v[112:115], v[48:51], 0
    ds_read_b128 v[136:139], v14 offset:0
    s_add_u32 m0, s62, 9216
    s_mov_b32 s54, 73728
    buffer_load_dwordx4 v2, s[28:31], s54 offen lds
    s_waitcnt vmcnt(6)
    ds_read_b64_tr_b16 v[60:61], v5 offset:3072
    ds_read_b64_tr_b16 v[62:63], v5 offset:3328
    s_waitcnt lgkmcnt(5)
    v_mfma_f32_32x32x16_bf16 v[152:167], v[116:119], v[52:55], v[152:167]
    ds_read_b128 v[140:143], v15 offset:0
    s_add_u32 m0, s62, 10240
    s_mov_b32 s54, 81920
    buffer_load_dwordx4 v2, s[28:31], s54 offen lds
    s_waitcnt vmcnt(6)
    ds_read_b64_tr_b16 v[64:65], v5 offset:4096
    ds_read_b64_tr_b16 v[66:67], v5 offset:4352
    s_waitcnt lgkmcnt(6)
    v_mfma_f32_32x32x16_bf16 v[152:167], v[120:123], v[56:59], v[152:167]
    ds_read_b128 v[144:147], v8 offset:256
    s_add_u32 m0, s62, 11264
    s_mov_b32 s54, 90112
    buffer_load_dwordx4 v2, s[28:31], s54 offen lds
    s_waitcnt vmcnt(6)
    ds_read_b64_tr_b16 v[68:69], v5 offset:5120
    ds_read_b64_tr_b16 v[70:71], v5 offset:5376
    s_waitcnt lgkmcnt(6)
    v_mfma_f32_32x32x16_bf16 v[152:167], v[124:127], v[60:63], v[152:167]
    ds_read_b128 v[148:151], v9 offset:256
    s_add_u32 m0, s62, 12288
    s_mov_b32 s54, 98304
    buffer_load_dwordx4 v2, s[28:31], s54 offen lds
    s_waitcnt vmcnt(6)
    ds_read_b64_tr_b16 v[72:73], v5 offset:6144
    ds_read_b64_tr_b16 v[74:75], v5 offset:6400
    s_waitcnt lgkmcnt(6)
    v_mfma_f32_32x32x16_bf16 v[152:167], v[128:131], v[64:67], v[152:167]
    ds_read_b128 v[112:115], v10 offset:256
    s_add_u32 m0, s62, 13312
    s_mov_b32 s54, 106496
    buffer_load_dwordx4 v2, s[28:31], s54 offen lds
    s_waitcnt vmcnt(6)
    ds_read_b64_tr_b16 v[76:77], v5 offset:7168
    ds_read_b64_tr_b16 v[78:79], v5 offset:7424
    s_waitcnt lgkmcnt(6)
    v_mfma_f32_32x32x16_bf16 v[152:167], v[132:135], v[68:71], v[152:167]
    ds_read_b128 v[116:119], v11 offset:256
    s_add_u32 m0, s62, 14336
    s_mov_b32 s54, 114688
    buffer_load_dwordx4 v2, s[28:31], s54 offen lds
    s_waitcnt vmcnt(6)
    ds_read_b64_tr_b16 v[80:81], v5 offset:8192
    ds_read_b64_tr_b16 v[82:83], v5 offset:8448
    s_waitcnt lgkmcnt(6)
    v_mfma_f32_32x32x16_bf16 v[152:167], v[136:139], v[72:75], v[152:167]
    ds_read_b128 v[120:123], v12 offset:256
    s_add_u32 m0, s62, 15360
    s_mov_b32 s54, 122880
    buffer_load_dwordx4 v2, s[28:31], s54 offen lds
    s_waitcnt vmcnt(6)
    ds_read_b64_tr_b16 v[84:85], v5 offset:9216
    ds_read_b64_tr_b16 v[86:87], v5 offset:9472
    s_waitcnt lgkmcnt(6)
    v_mfma_f32_32x32x16_bf16 v[152:167], v[140:143], v[76:79], v[152:167]
    ds_read_b128 v[124:127], v13 offset:256
    s_add_u32 m0, s60, 147456
    s_add_u32 s54, s59, 16384
    buffer_load_dwordx4 v3, s[32:35], s54 offen lds
    s_add_u32 m0, s60, 148480
    s_add_u32 s54, s59, 16384
    buffer_load_dwordx4 v4, s[32:35], s54 offen lds
    s_waitcnt vmcnt(7)
    ds_read_b64_tr_b16 v[88:89], v5 offset:10240
    ds_read_b64_tr_b16 v[90:91], v5 offset:10496
    s_waitcnt lgkmcnt(6)
    v_mfma_f32_32x32x16_bf16 v[152:167], v[144:147], v[80:83], v[152:167]
    ds_read_b128 v[128:131], v14 offset:256
    s_add_u32 s54, s59, 32768
    buffer_load_dwordx4 v[24:27], v3, s[32:35], s54 offen
    buffer_load_dwordx4 v[28:31], v4, s[32:35], s54 offen
    s_waitcnt vmcnt(8)
    ds_read_b64_tr_b16 v[92:93], v5 offset:11264
    ds_read_b64_tr_b16 v[94:95], v5 offset:11520
    s_waitcnt lgkmcnt(6)
    v_mfma_f32_32x32x16_bf16 v[152:167], v[148:151], v[84:87], v[152:167]
    ds_read_b128 v[132:135], v15 offset:256
    s_add_u32 s54, s59, 49152
    buffer_load_dwordx4 v[32:35], v3, s[32:35], s54 offen
    buffer_load_dwordx4 v[36:39], v4, s[32:35], s54 offen
    s_waitcnt vmcnt(9)
    ds_read_b64_tr_b16 v[96:97], v5 offset:12288
    ds_read_b64_tr_b16 v[98:99], v5 offset:12544
    s_waitcnt lgkmcnt(6)
    v_mfma_f32_32x32x16_bf16 v[152:167], v[112:115], v[88:91], v[152:167]
    s_add_u32 s54, s59, 65536
    buffer_load_dwordx4 v[40:43], v3, s[32:35], s54 offen
    buffer_load_dwordx4 v[44:47], v4, s[32:35], s54 offen
    s_waitcnt vmcnt(10)
    ds_read_b64_tr_b16 v[100:101], v5 offset:13312
    ds_read_b64_tr_b16 v[102:103], v5 offset:13568
    s_waitcnt lgkmcnt(5)
    v_mfma_f32_32x32x16_bf16 v[152:167], v[116:119], v[92:95], v[152:167]
    s_waitcnt vmcnt(9)
    ds_read_b64_tr_b16 v[104:105], v5 offset:14336
    ds_read_b64_tr_b16 v[106:107], v5 offset:14592
    s_waitcnt lgkmcnt(4)
    v_mfma_f32_32x32x16_bf16 v[152:167], v[120:123], v[96:99], v[152:167]
    s_waitcnt vmcnt(8)
    ds_read_b64_tr_b16 v[108:109], v5 offset:15360
    ds_read_b64_tr_b16 v[110:111], v5 offset:15616
    s_waitcnt lgkmcnt(4)
    v_mfma_f32_32x32x16_bf16 v[152:167], v[124:127], v[100:103], v[152:167]
    s_waitcnt lgkmcnt(2)
    v_mfma_f32_32x32x16_bf16 v[152:167], v[128:131], v[104:107], v[152:167]
    s_waitcnt lgkmcnt(0)
    v_mfma_f32_32x32x16_bf16 v[152:167], v[132:135], v[108:111], v[152:167]
    s_waitcnt vmcnt(6)
    s_barrier
    ds_read_b128 v[136:139], v8 offset:16384
    ds_read_b128 v[140:143], v9 offset:16384
    ds_read_b128 v[144:147], v10 offset:16384
    ds_read_b128 v[148:151], v11 offset:16384
    ds_read_b128 v[112:115], v12 offset:16384
    ds_read_b128 v[116:119], v13 offset:16384
    s_waitcnt lgkmcnt(5)
    v_mfma_f32_32x32x16_bf16 v[168:183], v[136:139], v[48:51], 0
    ds_read_b128 v[120:123], v14 offset:16384
    ds_read_b128 v[124:127], v15 offset:16384
    ds_read_b128 v[128:131], v8 offset:16640
    s_waitcnt lgkmcnt(7)
    v_mfma_f32_32x32x16_bf16 v[168:183], v[140:143], v[52:55], v[168:183]
    ds_read_b128 v[132:135], v9 offset:16640
    s_waitcnt lgkmcnt(7)
    v_mfma_f32_32x32x16_bf16 v[168:183], v[144:147], v[56:59], v[168:183]
    ds_read_b128 v[136:139], v10 offset:16640
    s_waitcnt lgkmcnt(7)
    v_mfma_f32_32x32x16_bf16 v[168:183], v[148:151], v[60:63], v[168:183]
    ds_read_b128 v[140:143], v11 offset:16640
    s_waitcnt lgkmcnt(7)
    v_mfma_f32_32x32x16_bf16 v[168:183], v[112:115], v[64:67], v[168:183]
    ds_read_b128 v[144:147], v12 offset:16640
    s_waitcnt lgkmcnt(7)
    v_mfma_f32_32x32x16_bf16 v[168:183], v[116:119], v[68:71], v[168:183]
    ds_read_b128 v[148:151], v13 offset:16640
    v_mul_f32 v152, s56, v152
    v_mul_f32 v153, s56, v153
    v_mul_f32 v154, s56, v154
    s_waitcnt lgkmcnt(7)
    v_mfma_f32_32x32x16_bf16 v[168:183], v[120:123], v[72:75], v[168:183]
    ds_read_b128 v[112:115], v14 offset:16640
    v_mul_f32 v155, s56, v155
    v_mul_f32 v156, s56, v156
    v_mul_f32 v157, s56, v157
    s_waitcnt lgkmcnt(7)
    v_mfma_f32_32x32x16_bf16 v[168:183], v[124:127], v[76:79], v[168:183]
    ds_read_b128 v[116:119], v15 offset:16640
    v_mul_f32 v158, s56, v158
    v_mul_f32 v159, s56, v159
    v_mul_f32 v160, s56, v160
    s_waitcnt lgkmcnt(7)
    v_mfma_f32_32x32x16_bf16 v[168:183], v[128:131], v[80:83], v[168:183]
    v_mul_f32 v161, s56, v161
    v_mul_f32 v162, s56, v162
    v_mul_f32 v163, s56, v163
    s_waitcnt lgkmcnt(6)
    v_mfma_f32_32x32x16_bf16 v[168:183], v[132:135], v[84:87], v[168:183]
    v_mul_f32 v164, s56, v164
    v_mul_f32 v165, s56, v165
    v_mul_f32 v166, s56, v166
    s_waitcnt lgkmcnt(5)
    v_mfma_f32_32x32x16_bf16 v[168:183], v[136:139], v[88:91], v[168:183]
    v_mul_f32 v167, s56, v167
    v_cvt_pk_bf16_f32 v184, v152, v153
    v_cvt_pk_bf16_f32 v185, v154, v155
    s_waitcnt lgkmcnt(4)
    v_mfma_f32_32x32x16_bf16 v[168:183], v[140:143], v[92:95], v[168:183]
    v_cvt_pk_bf16_f32 v186, v156, v157
    v_cvt_pk_bf16_f32 v187, v158, v159
    v_cvt_pk_bf16_f32 v188, v160, v161
    s_waitcnt lgkmcnt(3)
    v_mfma_f32_32x32x16_bf16 v[168:183], v[144:147], v[96:99], v[168:183]
    v_cvt_pk_bf16_f32 v189, v162, v163
    v_cvt_pk_bf16_f32 v190, v164, v165
    v_cvt_pk_bf16_f32 v191, v166, v167
    s_waitcnt lgkmcnt(2)
    v_mfma_f32_32x32x16_bf16 v[168:183], v[148:151], v[100:103], v[168:183]
    s_nop 1
    v_permlane32_swap_b32 v184, v186
    v_permlane32_swap_b32 v185, v187
    s_waitcnt lgkmcnt(1)
    v_mfma_f32_32x32x16_bf16 v[168:183], v[112:115], v[104:107], v[168:183]
    v_permlane32_swap_b32 v188, v190
    v_permlane32_swap_b32 v189, v191
    s_add_u32 s54, s61, 0
    s_waitcnt lgkmcnt(0)
    v_mfma_f32_32x32x16_bf16 v[168:183], v[116:119], v[108:111], v[168:183]
    buffer_store_dwordx4 v[184:187], v17, s[36:39], s54 offen sc1
    s_add_u32 s54, s61, 8192
    buffer_store_dwordx4 v[188:191], v17, s[36:39], s54 offen sc1
    v_add_u32 v8, 0xfffe0000, v8
    v_add_u32 v9, 0xfffe0000, v9
    v_add_u32 v10, 0xfffe0000, v10
    v_add_u32 v11, 0xfffe0000, v11
    v_add_u32 v12, 0xfffe0000, v12
    v_add_u32 v13, 0xfffe0000, v13
    v_add_u32 v14, 0xfffe0000, v14
    v_add_u32 v15, 0xfffe0000, v15
    s_waitcnt vmcnt(2)
    v_lshlrev_b32 v21, 4, v1
    v_add_u32 v21, s60, v21
    ds_write_b128 v21, v[24:27] offset:0
    ds_write_b128 v21, v[28:31] offset:1024
    ds_write_b128 v21, v[32:35] offset:16384
    ds_write_b128 v21, v[36:39] offset:17408
    ds_write_b128 v21, v[40:43] offset:32768
    ds_write_b128 v21, v[44:47] offset:33792
    s_waitcnt lgkmcnt(0)
    s_barrier
    s_cmp_lg_u32 s3, 0
    s_cbranch_scc1 L1_peek_P
    s_mov_b32 s48, s24
    s_mov_b32 s49, s25
    s_mov_b32 s50, 256
    s_mov_b32 s51, 0x20000
    v_mov_b32 v22, 0
    s_mov_b32 exec_lo, 1
    s_mov_b32 exec_hi, 0
    buffer_load_dword v23, v22, s[48:51], 0 offen sc1
    s_mov_b64 exec, -1
L1_peek_P:
    ds_read_b128 v[120:123], v8 offset:0
    ds_read_b128 v[124:127], v9 offset:0
    ds_read_b128 v[128:131], v10 offset:0
    ds_read_b128 v[132:135], v11 offset:0
    ds_read_b128 v[136:139], v12 offset:0
    ds_read_b128 v[140:143], v13 offset:0
    ds_read_b128 v[144:147], v14 offset:0
    ds_read_b128 v[148:151], v15 offset:0
    s_waitcnt lgkmcnt(7)
    v_mfma_f32_32x32x16_bf16 v[152:167], v[120:123], v[48:51], 0
    ds_read_b128 v[112:115], v8 offset:256
    s_waitcnt lgkmcnt(7)
    v_mfma_f32_32x32x16_bf16 v[152:167], v[124:127], v[52:55], v[152:167]
    ds_read_b128 v[116:119], v9 offset:256
    s_waitcnt lgkmcnt(7)
    v_mfma_f32_32x32x16_bf16 v[152:167], v[128:131], v[56:59], v[152:167]
    ds_read_b128 v[120:123], v10 offset:256
    s_waitcnt lgkmcnt(7)
    v_mfma_f32_32x32x16_bf16 v[152:167], v[132:135], v[60:63], v[152:167]
    ds_read_b128 v[124:127], v11 offset:256
    s_waitcnt lgkmcnt(7)
    v_mfma_f32_32x32x16_bf16 v[152:167], v[136:139], v[64:67], v[152:167]
    ds_read_b128 v[128:131], v12 offset:256
    s_waitcnt lgkmcnt(7)
    v_mfma_f32_32x32x16_bf16 v[152:167], v[140:143], v[68:71], v[152:167]
    ds_read_b128 v[132:135], v13 offset:256
    v_mul_f32 v168, s56, v168
    v_mul_f32 v169, s56, v169
    v_mul_f32 v170, s56, v170
    s_waitcnt lgkmcnt(7)
    v_mfma_f32_32x32x16_bf16 v[152:167], v[144:147], v[72:75], v[152:167]
    ds_read_b128 v[136:139], v14 offset:256
    v_mul_f32 v171, s56, v171
    v_mul_f32 v172, s56, v172
    v_mul_f32 v173, s56, v173
    s_waitcnt lgkmcnt(7)
    v_mfma_f32_32x32x16_bf16 v[152:167], v[148:151], v[76:79], v[152:167]
    ds_read_b128 v[140:143], v15 offset:256
    v_mul_f32 v174, s56, v174
    v_mul_f32 v175, s56, v175
    v_mul_f32 v176, s56, v176
    s_waitcnt lgkmcnt(7)
    v_mfma_f32_32x32x16_bf16 v[152:167], v[112:115], v[80:83], v[152:167]
    ds_read_b128 v[144:147], v8 offset:16384
    v_mul_f32 v177, s56, v177
    v_mul_f32 v178, s56, v178
    v_mul_f32 v179, s56, v179
    s_waitcnt lgkmcnt(7)
    v_mfma_f32_32x32x16_bf16 v[152:167], v[116:119], v[84:87], v[152:167]
    ds_read_b128 v[148:151], v9 offset:16384
    v_mul_f32 v180, s56, v180
    v_mul_f32 v181, s56, v181
    v_mul_f32 v182, s56, v182
    s_waitcnt lgkmcnt(7)
    v_mfma_f32_32x32x16_bf16 v[152:167], v[120:123], v[88:91], v[152:167]
    ds_read_b128 v[112:115], v10 offset:16384
    v_mul_f32 v183, s56, v183
    v_cvt_pk_bf16_f32 v184, v168, v169
    v_cvt_pk_bf16_f32 v185, v170, v171
    s_waitcnt lgkmcnt(7)
    v_mfma_f32_32x32x16_bf16 v[152:167], v[124:127], v[92:95], v[152:167]
    ds_read_b128 v[116:119], v11 offset:16384
    v_cvt_pk_bf16_f32 v186, v172, v173
    v_cvt_pk_bf16_f32 v187, v174, v175
    v_cvt_pk_bf16_f32 v188, v176, v177
    s_waitcnt lgkmcnt(7)
    v_mfma_f32_32x32x16_bf16 v[152:167], v[128:131], v[96:99], v[152:167]
    ds_read_b128 v[120:123], v12 offset:16384
    v_cvt_pk_bf16_f32 v189, v178, v179
    v_cvt_pk_bf16_f32 v190, v180, v181
    v_cvt_pk_bf16_f32 v191, v182, v183
    s_waitcnt lgkmcnt(7)
    v_mfma_f32_32x32x16_bf16 v[152:167], v[132:135], v[100:103], v[152:167]
    ds_read_b128 v[124:127], v13 offset:16384
    s_nop 1
    v_permlane32_swap_b32 v184, v186
    v_permlane32_swap_b32 v185, v187
    s_waitcnt lgkmcnt(7)
    v_mfma_f32_32x32x16_bf16 v[152:167], v[136:139], v[104:107], v[152:167]
    ds_read_b128 v[128:131], v14 offset:16384
    v_permlane32_swap_b32 v188, v190
    v_permlane32_swap_b32 v189, v191
    s_add_u32 s54, s61, 16384
    s_waitcnt lgkmcnt(7)
    v_mfma_f32_32x32x16_bf16 v[152:167], v[140:143], v[108:111], v[152:167]
    ds_read_b128 v[132:135], v15 offset:16384
    buffer_store_dwordx4 v[184:187], v17, s[36:39], s54 offen sc1
    s_add_u32 s54, s61, 24576
    buffer_store_dwordx4 v[188:191], v17, s[36:39], s54 offen sc1
    s_waitcnt lgkmcnt(7)
    v_mfma_f32_32x32x16_bf16 v[168:183], v[144:147], v[48:51], 0
    ds_read_b128 v[136:139], v8 offset:16640
    s_waitcnt lgkmcnt(7)
    v_mfma_f32_32x32x16_bf16 v[168:183], v[148:151], v[52:55], v[168:183]
    ds_read_b128 v[140:143], v9 offset:16640
    s_waitcnt lgkmcnt(7)
    v_mfma_f32_32x32x16_bf16 v[168:183], v[112:115], v[56:59], v[168:183]
    ds_read_b128 v[144:147], v10 offset:16640
    v_and_b32 v241, 31, v1
    v_lshrrev_b32 v242, 5, v1
    s_lshl_b32 s80, s3, 13
    s_add_u32 s80, s80, 73216
    v_bfe_u32 v243, v241, 2, 2
    v_xor_b32 v244, v242, v243
    v_lshlrev_b32 v245, 6, v241
    s_waitcnt lgkmcnt(7)
    v_mfma_f32_32x32x16_bf16 v[168:183], v[116:119], v[60:63], v[168:183]
    ds_read_b128 v[148:151], v11 offset:16640
    v_add_u32 v246, s80, v245
    v_lshl_add_u32 v214, v244, 4, v246
    v_xor_b32 v244, 2, v244
    v_lshl_add_u32 v215, v244, 4, v246
    v_lshlrev_b32 v244, 4, v241
    v_add_u32 v244, 2048, v244
    v_lshl_add_u32 v245, v243, 4, v245
    s_waitcnt lgkmcnt(7)
    v_mfma_f32_32x32x16_bf16 v[168:183], v[120:123], v[64:67], v[168:183]
    ds_read_b128 v[112:115], v12 offset:16640
    v_cmp_eq_u32 vcc, 1, v242
    v_bfe_u32 v243, v1, 2, 2
    v_lshl_add_u32 v243, v242, 2, v243
    v_cndmask_b32 v225, v244, v245, vcc
    v_lshlrev_b32 v243, 6, v243
    v_and_b32 v244, 1, v1
    s_waitcnt lgkmcnt(7)
    v_mfma_f32_32x32x16_bf16 v[168:183], v[124:127], v[68:71], v[168:183]
    ds_read_b128 v[116:119], v13 offset:16640
    v_lshl_add_u32 v243, v244, 3, v243
    v_bfe_u32 v244, v1, 4, 1
    v_lshlrev_b32 v244, 1, v244
    v_bfe_u32 v245, v1, 1, 1
    v_or_b32 v244, v244, v245
    v_xor_b32 v244, v244, v242
    v_mul_f32 v152, s56, v152
    v_mul_f32 v153, s56, v153
    v_mul_f32 v154, s56, v154
    s_waitcnt lgkmcnt(7)
    v_mfma_f32_32x32x16_bf16 v[168:183], v[128:131], v[72:75], v[168:183]
    ds_read_b128 v[120:123], v14 offset:16640
    v_lshl_add_u32 v226, v244, 4, v243
    v_xor_b32 v244, 2, v244
    v_lshl_add_u32 v245, v244, 4, v243
    v_add_u32 v227, 512, v245
    v_and_b32 v243, 3, v1
    v_bfe_u32 v244, v1, 4, 2
    v_mul_f32 v155, s56, v155
    v_mul_f32 v156, s56, v156
    v_mul_f32 v157, s56, v157
    s_waitcnt lgkmcnt(7)
    v_mfma_f32_32x32x16_bf16 v[168:183], v[132:135], v[76:79], v[168:183]
    ds_read_b128 v[124:127], v15 offset:16640
    v_xor_b32 v243, v243, v244
    v_lshlrev_b32 v243, 4, v243
    s_lshl_b32 s52, s3, 6
    s_sub_u32 s53, s52, 512
    v_add_u32 v220, s53, v243
    v_and_b32 v243, 7, v1
    v_mul_f32 v158, s56, v158
    v_mul_f32 v159, s56, v159
    v_mul_f32 v160, s56, v160
    s_waitcnt lgkmcnt(7)
    v_mfma_f32_32x32x16_bf16 v[168:183], v[136:139], v[80:83], v[168:183]
    ds_read_b128 v[128:131], v8 offset:32768
    v_mul_u32_u24 v243, 544, v243
    v_lshl_add_u32 v243, v242, 5, v243
    s_add_u32 s52, s52, 138752
    v_add_u32 v221, s52, v243
    v_lshlrev_b32 v243, 2, v241
    v_add_u32 v222, 160512, v243
    v_mul_f32 v161, s56, v161
    v_mul_f32 v162, s56, v162
    v_mul_f32 v163, s56, v163
    s_waitcnt lgkmcnt(7)
    v_mfma_f32_32x32x16_bf16 v[168:183], v[140:143], v[84:87], v[168:183]
    ds_read_b128 v[132:135], v9 offset:32768
    v_lshrrev_b32 v243, 2, v1
    v_lshlrev_b32 v243, 2, v243
    v_add_u32 v240, 69120, v243
    v_and_b32 v241, 31, v1
    v_lshrrev_b32 v242, 5, v1
    v_mov_b32 v208, 1.0
    v_mul_f32 v164, s56, v164
    v_mul_f32 v165, s56, v165
    v_mul_f32 v166, s56, v166
    s_waitcnt lgkmcnt(7)
    v_mfma_f32_32x32x16_bf16 v[168:183], v[144:147], v[88:91], v[168:183]
    ds_read_b128 v[136:139], v10 offset:32768
    v_mov_b32 v209, 1.0
    v_mov_b32 v236, 0
    v_mov_b32 v237, 0
    v_mov_b32 v238, 0
    v_mov_b32 v239, 0
    s_mov_b32 s86, 0xff
    v_mul_f32 v167, s56, v167
    v_cvt_pk_bf16_f32 v184, v152, v153
    v_cvt_pk_bf16_f32 v185, v154, v155
    s_waitcnt lgkmcnt(7)
    v_mfma_f32_32x32x16_bf16 v[168:183], v[148:151], v[92:95], v[168:183]
    ds_read_b128 v[140:143], v11 offset:32768
    s_mov_b32 s87, 0xff
    v_lshlrev_b32 v243, 3, v242
    v_sub_u32 v243, v241, v243
    v_mov_b32 v245, 0x3f80
    v_mov_b32 v246, 0x3f800000
    v_and_b32 v244, 1, v243
    v_cvt_pk_bf16_f32 v186, v156, v157
    v_cvt_pk_bf16_f32 v187, v158, v159
    v_cvt_pk_bf16_f32 v188, v160, v161
    s_waitcnt lgkmcnt(7)
    v_mfma_f32_32x32x16_bf16 v[168:183], v[112:115], v[96:99], v[168:183]
    ds_read_b128 v[144:147], v12 offset:32768
    v_cmp_eq_u32 vcc, 1, v244
    v_lshrrev_b32 v247, 1, v243
    v_add_u32 v248, -8, v247
    v_cndmask_b32 v244, v245, v246, vcc
    v_cmp_eq_u32 s[64:65], 0, v247
    v_cmp_eq_u32 s[66:67], 1, v247
    v_cvt_pk_bf16_f32 v189, v162, v163
    v_cvt_pk_bf16_f32 v190, v164, v165
    v_cvt_pk_bf16_f32 v191, v166, v167
    s_waitcnt lgkmcnt(7)
    v_mfma_f32_32x32x16_bf16 v[168:183], v[116:119], v[100:103], v[168:183]
    ds_read_b128 v[148:151], v13 offset:32768
    s_nop 0
    v_cndmask_b32 v200, 0, v244, s[64:65]
    v_cndmask_b32 v201, 0, v244, s[66:67]
    v_cmp_eq_u32 s[64:65], 2, v247
    v_cmp_eq_u32 s[66:67], 3, v247
    s_nop 0
    s_nop 1
    v_permlane32_swap_b32 v184, v186
    v_permlane32_swap_b32 v185, v187
    s_waitcnt lgkmcnt(7)
    v_mfma_f32_32x32x16_bf16 v[168:183], v[120:123], v[104:107], v[168:183]
    ds_read_b128 v[112:115], v14 offset:32768
    v_cndmask_b32 v202, 0, v244, s[64:65]
    v_cndmask_b32 v203, 0, v244, s[66:67]
    v_cmp_eq_u32 s[64:65], 0, v248
    v_cmp_eq_u32 s[66:67], 1, v248
    s_nop 0
    v_cndmask_b32 v204, 0, v244, s[64:65]
    v_permlane32_swap_b32 v188, v190
    v_permlane32_swap_b32 v189, v191
    s_add_u32 s54, s61, 32768
    s_waitcnt lgkmcnt(7)
    v_mfma_f32_32x32x16_bf16 v[168:183], v[124:127], v[108:111], v[168:183]
    ds_read_b128 v[116:119], v15 offset:32768
    v_cndmask_b32 v205, 0, v244, s[66:67]
    v_cmp_eq_u32 s[64:65], 2, v248
    v_cmp_eq_u32 s[66:67], 3, v248
    s_nop 0
    v_cndmask_b32 v206, 0, v244, s[64:65]
    v_cndmask_b32 v207, 0, v244, s[66:67]
    buffer_store_dwordx4 v[184:187], v17, s[36:39], s54 offen sc1
    s_add_u32 s54, s61, 40960
    buffer_store_dwordx4 v[188:191], v17, s[36:39], s54 offen sc1
    s_waitcnt lgkmcnt(7)
    v_mfma_f32_32x32x16_bf16 v[152:167], v[128:131], v[48:51], 0
    ds_read_b128 v[120:123], v8 offset:33024
    s_waitcnt lgkmcnt(7)
    v_mfma_f32_32x32x16_bf16 v[152:167], v[132:135], v[52:55], v[152:167]
    ds_read_b128 v[124:127], v9 offset:33024
    s_waitcnt lgkmcnt(7)
    v_mfma_f32_32x32x16_bf16 v[152:167], v[136:139], v[56:59], v[152:167]
    ds_read_b128 v[128:131], v10 offset:33024
    s_waitcnt lgkmcnt(7)
    v_mfma_f32_32x32x16_bf16 v[152:167], v[140:143], v[60:63], v[152:167]
    ds_read_b128 v[132:135], v11 offset:33024
    s_waitcnt lgkmcnt(7)
    v_mfma_f32_32x32x16_bf16 v[152:167], v[144:147], v[64:67], v[152:167]
    ds_read_b128 v[136:139], v12 offset:33024
    s_waitcnt lgkmcnt(7)
    v_mfma_f32_32x32x16_bf16 v[152:167], v[148:151], v[68:71], v[152:167]
    ds_read_b128 v[140:143], v13 offset:33024
    v_mul_f32 v168, s56, v168
    v_mul_f32 v169, s56, v169
    v_mul_f32 v170, s56, v170
    s_waitcnt lgkmcnt(7)
    v_mfma_f32_32x32x16_bf16 v[152:167], v[112:115], v[72:75], v[152:167]
    ds_read_b128 v[144:147], v14 offset:33024
    v_mul_f32 v171, s56, v171
    v_mul_f32 v172, s56, v172
    v_mul_f32 v173, s56, v173
    s_waitcnt lgkmcnt(7)
    v_mfma_f32_32x32x16_bf16 v[152:167], v[116:119], v[76:79], v[152:167]
    ds_read_b128 v[148:151], v15 offset:33024
    v_mul_f32 v174, s56, v174
    v_mul_f32 v175, s56, v175
    v_mul_f32 v176, s56, v176
    s_waitcnt lgkmcnt(7)
    v_mfma_f32_32x32x16_bf16 v[152:167], v[120:123], v[80:83], v[152:167]
    v_mul_f32 v177, s56, v177
    v_mul_f32 v178, s56, v178
    v_mul_f32 v179, s56, v179
    s_waitcnt lgkmcnt(6)
    v_mfma_f32_32x32x16_bf16 v[152:167], v[124:127], v[84:87], v[152:167]
    v_mul_f32 v180, s56, v180
    v_mul_f32 v181, s56, v181
    v_mul_f32 v182, s56, v182
    s_waitcnt lgkmcnt(5)
    v_mfma_f32_32x32x16_bf16 v[152:167], v[128:131], v[88:91], v[152:167]
    v_mul_f32 v183, s56, v183
    v_cvt_pk_bf16_f32 v184, v168, v169
    v_cvt_pk_bf16_f32 v185, v170, v171
    s_waitcnt lgkmcnt(4)
    v_mfma_f32_32x32x16_bf16 v[152:167], v[132:135], v[92:95], v[152:167]
    v_cvt_pk_bf16_f32 v186, v172, v173
    v_cvt_pk_bf16_f32 v187, v174, v175
    v_cvt_pk_bf16_f32 v188, v176, v177
    s_waitcnt lgkmcnt(3)
    v_mfma_f32_32x32x16_bf16 v[152:167], v[136:139], v[96:99], v[152:167]
    v_cvt_pk_bf16_f32 v189, v178, v179
    v_cvt_pk_bf16_f32 v190, v180, v181
    v_cvt_pk_bf16_f32 v191, v182, v183
    s_waitcnt lgkmcnt(2)
    v_mfma_f32_32x32x16_bf16 v[152:167], v[140:143], v[100:103], v[152:167]
    s_nop 1
    v_permlane32_swap_b32 v184, v186
    v_permlane32_swap_b32 v185, v187
    s_waitcnt lgkmcnt(1)
    v_mfma_f32_32x32x16_bf16 v[152:167], v[144:147], v[104:107], v[152:167]
    v_permlane32_swap_b32 v188, v190
    v_permlane32_swap_b32 v189, v191
    s_add_u32 s54, s61, 49152
    s_waitcnt lgkmcnt(0)
    v_mfma_f32_32x32x16_bf16 v[152:167], v[148:151], v[108:111], v[152:167]
    buffer_store_dwordx4 v[184:187], v17, s[36:39], s54 offen sc1
    s_add_u32 s54, s61, 57344
    buffer_store_dwordx4 v[188:191], v17, s[36:39], s54 offen sc1
    s_nop 7
    s_nop 3
    v_mul_f32 v152, s56, v152
    v_mul_f32 v153, s56, v153
    v_mul_f32 v154, s56, v154
    v_mul_f32 v155, s56, v155
    v_mul_f32 v156, s56, v156
    v_mul_f32 v157, s56, v157
    v_mul_f32 v158, s56, v158
    v_mul_f32 v159, s56, v159
    v_mul_f32 v160, s56, v160
    v_mul_f32 v161, s56, v161
    v_mul_f32 v162, s56, v162
    v_mul_f32 v163, s56, v163
    v_mul_f32 v164, s56, v164
    v_mul_f32 v165, s56, v165
    v_mul_f32 v166, s56, v166
    v_mul_f32 v167, s56, v167
    v_cvt_pk_bf16_f32 v184, v152, v153
    v_cvt_pk_bf16_f32 v185, v154, v155
    v_cvt_pk_bf16_f32 v186, v156, v157
    v_cvt_pk_bf16_f32 v187, v158, v159
    v_cvt_pk_bf16_f32 v188, v160, v161
    v_cvt_pk_bf16_f32 v189, v162, v163
    v_cvt_pk_bf16_f32 v190, v164, v165
    v_cvt_pk_bf16_f32 v191, v166, v167
    s_nop 1
    v_permlane32_swap_b32 v184, v186
    v_permlane32_swap_b32 v185, v187
    v_permlane32_swap_b32 v188, v190
    v_permlane32_swap_b32 v189, v191
    s_add_u32 s54, s61, 65536
    buffer_store_dwordx4 v[184:187], v17, s[36:39], s54 offen sc1
    s_add_u32 s54, s61, 73728
    buffer_store_dwordx4 v[188:191], v17, s[36:39], s54 offen sc1
    s_waitcnt lgkmcnt(0)
    s_barrier
    v_mov_b32 v36, 0
    v_mov_b32 v37, 0
    v_mov_b32 v38, 0
    v_mov_b32 v39, 0
    v_lshlrev_b32 v40, 4, v0
    v_add_u32 v41, 0x10000, v40
    ds_write_b128 v40, v[36:39] offset:0
    ds_write_b128 v40, v[36:39] offset:8192
    ds_write_b128 v40, v[36:39] offset:16384
    ds_write_b128 v40, v[36:39] offset:24576
    ds_write_b128 v40, v[36:39] offset:32768
    ds_write_b128 v40, v[36:39] offset:40960
    ds_write_b128 v40, v[36:39] offset:49152
    ds_write_b128 v40, v[36:39] offset:57344
    ds_write_b128 v41, v[36:39]
    s_cmp_eq_u32 s3, 0
    s_cbranch_scc0 1f
    v_add_u32 v41, 160512, v40
    s_mov_b32 exec_lo, -1
    s_mov_b32 exec_hi, 0xff
    ds_write_b128 v41, v[36:39]
    s_mov_b64 exec, -1
1:
    s_mov_b32 s84, 0x10000
    s_cmp_lg_u32 s3, 0
    s_cbranch_scc1 L1_peek2_P
    s_waitcnt vmcnt(0)
    v_and_b32 v23, 0xffff, v23
    v_mov_b32 v22, 163824
    s_mov_b32 exec_lo, 1
    s_mov_b32 exec_hi, 0
    ds_write_b32 v22, v23
    s_mov_b64 exec, -1
L1_peek2_P:
    s_waitcnt vmcnt(0) lgkmcnt(0)
    s_barrier
    v_mov_b32 v22, 163824
    ds_read_b32 v23, v22
    s_waitcnt lgkmcnt(0)
    v_readfirstlane_b32 s52, v23
    s_cmp_eq_u32 s52, 0x3c01
    s_cbranch_scc1 L_phase2_fast
    s_branch L_phase2
L1_gemm_Q:
    s_add_u32 s28, s14, 131072
    s_addc_u32 s29, s15, 0
    s_mov_b32 s30, 131072
    s_mov_b32 s31, 0x20000
    s_mov_b32 s32, s4
    s_mov_b32 s33, s5
    s_mov_b32 s34, 5120000
    s_mov_b32 s35, 0x20000
    v_lshrrev_b32 v2, 2, v1
    v_lshlrev_b32 v2, 9, v2
    v_and_b32 v3, 3, v1
    v_lshl_add_u32 v2, v3, 4, v2
    s_lshl_b32 s52, s3, 6
    v_add_u32 v2, s52, v2
    v_lshrrev_b32 v5, 5, v1
    s_lshl_b32 s52, s3, 2
    v_and_b32 v6, 31, v1
    v_add_u32 v7, s52, v5
    v_and_b32 v16, 15, v7
    v_xor_b32 v16, v16, v6
    v_lshlrev_b32 v16, 4, v16
    v_lshl_add_u32 v3, v7, 9, v16
    v_add_u32 v7, s52, v5
    v_add_u32 v7, 2, v7
    v_and_b32 v16, 15, v7
    v_xor_b32 v16, v16, v6
    v_lshlrev_b32 v16, 4, v16
    v_lshl_add_u32 v4, v7, 9, v16
    s_mul_i32 s59, s58, 81920
    s_lshl_b32 s60, s3, 11
    s_lshl_b32 s62, s3, 14
    s_setprio 3
    s_add_u32 m0, s60, 131072
    s_add_u32 s54, s59, 0
    buffer_load_dwordx4 v3, s[32:35], s54 offen lds
    s_add_u32 m0, s60, 132096
    s_add_u32 s54, s59, 0
    buffer_load_dwordx4 v4, s[32:35], s54 offen lds
    s_add_u32 m0, s62, 0
    s_mov_b32 s54, 0
    buffer_load_dwordx4 v2, s[28:31], s54 offen lds
    s_add_u32 m0, s62, 1024
    s_mov_b32 s54, 8192
    buffer_load_dwordx4 v2, s[28:31], s54 offen lds
    s_add_u32 m0, s62, 2048
    s_mov_b32 s54, 16384
    buffer_load_dwordx4 v2, s[28:31], s54 offen lds
    s_add_u32 m0, s62, 3072
    s_mov_b32 s54, 24576
    buffer_load_dwordx4 v2, s[28:31], s54 offen lds
    s_add_u32 m0, s62, 4096
    s_mov_b32 s54, 32768
    buffer_load_dwordx4 v2, s[28:31], s54 offen lds
    s_add_u32 m0, s62, 5120
    s_mov_b32 s54, 40960
    buffer_load_dwordx4 v2, s[28:31], s54 offen lds
    s_add_u32 m0, s62, 6144
    s_mov_b32 s54, 49152
    buffer_load_dwordx4 v2, s[28:31], s54 offen lds
    s_add_u32 m0, s62, 7168
    s_mov_b32 s54, 57344
    buffer_load_dwordx4 v2, s[28:31], s54 offen lds
    s_setprio 0
    s_mov_b32 s36, s20
    s_mov_b32 s37, s21
    s_mov_b32 s38, 5120000
    s_mov_b32 s39, 0x20000
    v_lshrrev_b32 v5, 5, v1
    v_bfe_u32 v6, v1, 2, 2
    v_lshl_add_u32 v6, v5, 3, v6
    v_lshlrev_b32 v6, 6, v6
    v_bfe_u32 v7, v1, 4, 1
    v_and_b32 v16, 3, v1
    v_lshl_add_u32 v7, v7, 2, v16
    v_and_b32 v16, 1, v7
    v_lshlrev_b32 v16, 5, v16
    v_lshrrev_b32 v7, 1, v7
    v_lshl_add_u32 v7, v7, 3, v16
    v_add_u32 v5, v6, v7
    s_lshl_b32 s53, s3, 14
    v_add_u32 v5, s53, v5
    v_and_b32 v6, 31, v1
    v_lshrrev_b32 v7, 5, v1
    v_and_b32 v16, 15, v6
    v_xor_b32 v7, v7, v16
    v_lshlrev_b32 v6, 9, v6
    v_add_u32 v6, 0x20000, v6
    v_xor_b32 v16, 0, v7
    v_lshl_add_u32 v8, v16, 4, v6
    v_xor_b32 v16, 2, v7
    v_lshl_add_u32 v9, v16, 4, v6
    v_xor_b32 v16, 4, v7
    v_lshl_add_u32 v10, v16, 4, v6
    v_xor_b32 v16, 6, v7
    v_lshl_add_u32 v11, v16, 4, v6
    v_xor_b32 v16, 8, v7
    v_lshl_add_u32 v12, v16, 4, v6
    v_xor_b32 v16, 10, v7
    v_lshl_add_u32 v13, v16, 4, v6
    v_xor_b32 v16, 12, v7
    v_lshl_add_u32 v14, v16, 4, v6
    v_xor_b32 v16, 14, v7
    v_lshl_add_u32 v15, v16, 4, v6
    v_and_b32 v6, 31, v1
    v_lshrrev_b32 v7, 5, v1
    s_mul_i32 s61, s58, 81920
    s_lshl_b32 s52, s3, 11
    s_add_u32 s52, s52, 81920
    v_bfe_u32 v16, v6, 1, 2
    v_lshlrev_b32 v19, 1, v7
    v_xor_b32 v19, v19, v16
    v_lshlrev_b32 v20, 6, v6
    v_add_u32 v20, s52, v20
    v_lshl_add_u32 v17, v19, 4, v20
    v_xor_b32 v19, 1, v19
    v_lshl_add_u32 v18, v19, 4, v20
    v_lshrrev_b32 v6, 2, v1
    v_bfe_u32 v16, v1, 3, 2
    v_and_b32 v7, 3, v1
    v_xor_b32 v16, v16, v7
    v_lshlrev_b32 v19, 6, v6
    v_lshl_add_u32 v19, v16, 4, v19
    v_add_u32 v19, s52, v19
    s_lshl_b32 s52, s3, 6
    v_lshlrev_b32 v20, 9, v6
    v_lshl_add_u32 v20, v7, 4, v20
    v_add_u32 v20, s52, v20
    s_mov_b32 s56, 0xbfb8aa3b
    s_waitcnt vmcnt(8)
    s_barrier
    ds_read_b128 v[112:115], v8 offset:0
    ds_read_b128 v[116:119], v9 offset:0
    ds_read_b128 v[120:123], v10 offset:0
    ds_read_b128 v[124:127], v11 offset:0
    ds_read_b128 v[128:131], v12 offset:0
    ds_read_b128 v[132:135], v13 offset:0
    s_waitcnt vmcnt(7)
    ds_read_b64_tr_b16 v[48:49], v5 offset:0
    ds_read_b64_tr_b16 v[50:51], v5 offset:256
    s_waitcnt vmcnt(6)
    ds_read_b64_tr_b16 v[52:53], v5 offset:1024
    ds_read_b64_tr_b16 v[54:55], v5 offset:1280
    s_add_u32 m0, s62, 8192
    s_mov_b32 s54, 65536
    buffer_load_dwordx4 v2, s[28:31], s54 offen lds
    s_waitcnt vmcnt(6)
    ds_read_b64_tr_b16 v[56:57], v5 offset:2048
    ds_read_b64_tr_b16 v[58:59], v5 offset:2304
    s_waitcnt lgkmcnt(4)
    v_mfma_f32_32x32x16_bf16 v[152:167], v[48:51], v[112:115], 0
    ds_read_b128 v[136:139], v14 offset:0
    s_add_u32 m0, s62, 9216
    s_mov_b32 s54, 73728
    buffer_load_dwordx4 v2, s[28:31], s54 offen lds
    s_waitcnt vmcnt(6)
    ds_read_b64_tr_b16 v[60:61], v5 offset:3072
    ds_read_b64_tr_b16 v[62:63], v5 offset:3328
    s_waitcnt lgkmcnt(5)
    v_mfma_f32_32x32x16_bf16 v[152:167], v[52:55], v[116:119], v[152:167]
    ds_read_b128 v[140:143], v15 offset:0
    s_add_u32 m0, s62, 10240
    s_mov_b32 s54, 81920
    buffer_load_dwordx4 v2, s[28:31], s54 offen lds
    s_waitcnt vmcnt(6)
    ds_read_b64_tr_b16 v[64:65], v5 offset:4096
    ds_read_b64_tr_b16 v[66:67], v5 offset:4352
    s_waitcnt lgkmcnt(6)
    v_mfma_f32_32x32x16_bf16 v[152:167], v[56:59], v[120:123], v[152:167]
    ds_read_b128 v[144:147], v8 offset:256
    s_add_u32 m0, s62, 11264
    s_mov_b32 s54, 90112
    buffer_load_dwordx4 v2, s[28:31], s54 offen lds
    s_waitcnt vmcnt(6)
    ds_read_b64_tr_b16 v[68:69], v5 offset:5120
    ds_read_b64_tr_b16 v[70:71], v5 offset:5376
    s_waitcnt lgkmcnt(6)
    v_mfma_f32_32x32x16_bf16 v[152:167], v[60:63], v[124:127], v[152:167]
    ds_read_b128 v[148:151], v9 offset:256
    s_add_u32 m0, s62, 12288
    s_mov_b32 s54, 98304
    buffer_load_dwordx4 v2, s[28:31], s54 offen lds
    s_waitcnt vmcnt(6)
    ds_read_b64_tr_b16 v[72:73], v5 offset:6144
    ds_read_b64_tr_b16 v[74:75], v5 offset:6400
    s_waitcnt lgkmcnt(6)
    v_mfma_f32_32x32x16_bf16 v[152:167], v[64:67], v[128:131], v[152:167]
    ds_read_b128 v[112:115], v10 offset:256
    s_add_u32 m0, s62, 13312
    s_mov_b32 s54, 106496
    buffer_load_dwordx4 v2, s[28:31], s54 offen lds
    s_waitcnt vmcnt(6)
    ds_read_b64_tr_b16 v[76:77], v5 offset:7168
    ds_read_b64_tr_b16 v[78:79], v5 offset:7424
    s_waitcnt lgkmcnt(6)
    v_mfma_f32_32x32x16_bf16 v[152:167], v[68:71], v[132:135], v[152:167]
    ds_read_b128 v[116:119], v11 offset:256
    s_add_u32 m0, s62, 14336
    s_mov_b32 s54, 114688
    buffer_load_dwordx4 v2, s[28:31], s54 offen lds
    s_waitcnt vmcnt(6)
    ds_read_b64_tr_b16 v[80:81], v5 offset:8192
    ds_read_b64_tr_b16 v[82:83], v5 offset:8448
    s_waitcnt lgkmcnt(6)
    v_mfma_f32_32x32x16_bf16 v[152:167], v[72:75], v[136:139], v[152:167]
    ds_read_b128 v[120:123], v12 offset:256
    s_add_u32 m0, s62, 15360
    s_mov_b32 s54, 122880
    buffer_load_dwordx4 v2, s[28:31], s54 offen lds
    s_waitcnt vmcnt(6)
    ds_read_b64_tr_b16 v[84:85], v5 offset:9216
    ds_read_b64_tr_b16 v[86:87], v5 offset:9472
    s_waitcnt lgkmcnt(6)
    v_mfma_f32_32x32x16_bf16 v[152:167], v[76:79], v[140:143], v[152:167]
    ds_read_b128 v[124:127], v13 offset:256
    s_add_u32 m0, s60, 147456
    s_add_u32 s54, s59, 16384
    buffer_load_dwordx4 v3, s[32:35], s54 offen lds
    s_add_u32 m0, s60, 148480
    s_add_u32 s54, s59, 16384
    buffer_load_dwordx4 v4, s[32:35], s54 offen lds
    s_waitcnt vmcnt(7)
    ds_read_b64_tr_b16 v[88:89], v5 offset:10240
    ds_read_b64_tr_b16 v[90:91], v5 offset:10496
    s_waitcnt lgkmcnt(6)
    v_mfma_f32_32x32x16_bf16 v[152:167], v[80:83], v[144:147], v[152:167]
    ds_read_b128 v[128:131], v14 offset:256
    s_add_u32 s54, s59, 32768
    buffer_load_dwordx4 v[24:27], v3, s[32:35], s54 offen
    buffer_load_dwordx4 v[28:31], v4, s[32:35], s54 offen
    s_waitcnt vmcnt(8)
    ds_read_b64_tr_b16 v[92:93], v5 offset:11264
    ds_read_b64_tr_b16 v[94:95], v5 offset:11520
    s_waitcnt lgkmcnt(6)
    v_mfma_f32_32x32x16_bf16 v[152:167], v[84:87], v[148:151], v[152:167]
    ds_read_b128 v[132:135], v15 offset:256
    s_add_u32 s54, s59, 49152
    buffer_load_dwordx4 v[32:35], v3, s[32:35], s54 offen
    buffer_load_dwordx4 v[36:39], v4, s[32:35], s54 offen
    s_waitcnt vmcnt(9)
    ds_read_b64_tr_b16 v[96:97], v5 offset:12288
    ds_read_b64_tr_b16 v[98:99], v5 offset:12544
    s_waitcnt lgkmcnt(6)
    v_mfma_f32_32x32x16_bf16 v[152:167], v[88:91], v[112:115], v[152:167]
    s_add_u32 s54, s59, 65536
    buffer_load_dwordx4 v[40:43], v3, s[32:35], s54 offen
    buffer_load_dwordx4 v[44:47], v4, s[32:35], s54 offen
    s_waitcnt vmcnt(10)
    ds_read_b64_tr_b16 v[100:101], v5 offset:13312
    ds_read_b64_tr_b16 v[102:103], v5 offset:13568
    s_waitcnt lgkmcnt(5)
    v_mfma_f32_32x32x16_bf16 v[152:167], v[92:95], v[116:119], v[152:167]
    s_waitcnt vmcnt(9)
    ds_read_b64_tr_b16 v[104:105], v5 offset:14336
    ds_read_b64_tr_b16 v[106:107], v5 offset:14592
    s_waitcnt lgkmcnt(4)
    v_mfma_f32_32x32x16_bf16 v[152:167], v[96:99], v[120:123], v[152:167]
    s_waitcnt vmcnt(8)
    ds_read_b64_tr_b16 v[108:109], v5 offset:15360
    ds_read_b64_tr_b16 v[110:111], v5 offset:15616
    s_waitcnt lgkmcnt(4)
    v_mfma_f32_32x32x16_bf16 v[152:167], v[100:103], v[124:127], v[152:167]
    s_waitcnt lgkmcnt(2)
    v_mfma_f32_32x32x16_bf16 v[152:167], v[104:107], v[128:131], v[152:167]
    s_waitcnt lgkmcnt(0)
    v_mfma_f32_32x32x16_bf16 v[152:167], v[108:111], v[132:135], v[152:167]
    s_waitcnt vmcnt(6)
    s_barrier
    ds_read_b128 v[136:139], v8 offset:16384
    ds_read_b128 v[140:143], v9 offset:16384
    ds_read_b128 v[144:147], v10 offset:16384
    ds_read_b128 v[148:151], v11 offset:16384
    ds_read_b128 v[112:115], v12 offset:16384
    ds_read_b128 v[116:119], v13 offset:16384
    s_waitcnt lgkmcnt(5)
    v_mfma_f32_32x32x16_bf16 v[168:183], v[48:51], v[136:139], 0
    ds_read_b128 v[120:123], v14 offset:16384
    ds_read_b128 v[124:127], v15 offset:16384
    ds_read_b128 v[128:131], v8 offset:16640
    s_waitcnt lgkmcnt(7)
    v_mfma_f32_32x32x16_bf16 v[168:183], v[52:55], v[140:143], v[168:183]
    ds_read_b128 v[132:135], v9 offset:16640
    s_waitcnt lgkmcnt(7)
    v_mfma_f32_32x32x16_bf16 v[168:183], v[56:59], v[144:147], v[168:183]
    ds_read_b128 v[136:139], v10 offset:16640
    s_waitcnt lgkmcnt(7)
    v_mfma_f32_32x32x16_bf16 v[168:183], v[60:63], v[148:151], v[168:183]
    ds_read_b128 v[140:143], v11 offset:16640
    s_waitcnt lgkmcnt(7)
    v_mfma_f32_32x32x16_bf16 v[168:183], v[64:67], v[112:115], v[168:183]
    ds_read_b128 v[144:147], v12 offset:16640
    s_waitcnt lgkmcnt(7)
    v_mfma_f32_32x32x16_bf16 v[168:183], v[68:71], v[116:119], v[168:183]
    ds_read_b128 v[148:151], v13 offset:16640
    v_mul_f32 v152, s56, v152
    v_mul_f32 v153, s56, v153
    v_mul_f32 v154, s56, v154
    v_mul_f32 v155, s56, v155
    s_waitcnt lgkmcnt(7)
    v_mfma_f32_32x32x16_bf16 v[168:183], v[72:75], v[120:123], v[168:183]
    ds_read_b128 v[112:115], v14 offset:16640
    v_mul_f32 v156, s56, v156
    v_mul_f32 v157, s56, v157
    v_mul_f32 v158, s56, v158
    v_mul_f32 v159, s56, v159
    s_waitcnt lgkmcnt(7)
    v_mfma_f32_32x32x16_bf16 v[168:183], v[76:79], v[124:127], v[168:183]
    ds_read_b128 v[116:119], v15 offset:16640
    v_mul_f32 v160, s56, v160
    v_mul_f32 v161, s56, v161
    v_mul_f32 v162, s56, v162
    s_waitcnt lgkmcnt(7)
    v_mfma_f32_32x32x16_bf16 v[168:183], v[80:83], v[128:131], v[168:183]
    v_mul_f32 v163, s56, v163
    v_mul_f32 v164, s56, v164
    v_mul_f32 v165, s56, v165
    s_waitcnt lgkmcnt(6)
    v_mfma_f32_32x32x16_bf16 v[168:183], v[84:87], v[132:135], v[168:183]
    v_mul_f32 v166, s56, v166
    v_mul_f32 v167, s56, v167
    v_cvt_pk_bf16_f32 v184, v152, v153
    s_waitcnt lgkmcnt(5)
    v_mfma_f32_32x32x16_bf16 v[168:183], v[88:91], v[136:139], v[168:183]
    v_cvt_pk_bf16_f32 v185, v154, v155
    v_cvt_pk_bf16_f32 v186, v156, v157
    v_cvt_pk_bf16_f32 v187, v158, v159
    s_waitcnt lgkmcnt(4)
    v_mfma_f32_32x32x16_bf16 v[168:183], v[92:95], v[140:143], v[168:183]
    v_cvt_pk_bf16_f32 v188, v160, v161
    v_cvt_pk_bf16_f32 v189, v162, v163
    v_cvt_pk_bf16_f32 v190, v164, v165
    s_waitcnt lgkmcnt(3)
    v_mfma_f32_32x32x16_bf16 v[168:183], v[96:99], v[144:147], v[168:183]
    v_cvt_pk_bf16_f32 v191, v166, v167
    ds_write_b128 v17, v[184:187]
    ds_write_b128 v18, v[188:191]
    s_waitcnt lgkmcnt(4)
    v_mfma_f32_32x32x16_bf16 v[168:183], v[100:103], v[148:151], v[168:183]
    s_waitcnt lgkmcnt(0)
    ds_read_b128 v[192:195], v19
    ds_read_b128 v[196:199], v19 offset:1024
    v_mfma_f32_32x32x16_bf16 v[168:183], v[104:107], v[112:115], v[168:183]
    s_add_u32 s54, s61, 0
    s_waitcnt lgkmcnt(1)
    buffer_store_dwordx4 v[192:195], v20, s[36:39], s54 offen sc1
    v_mfma_f32_32x32x16_bf16 v[168:183], v[108:111], v[116:119], v[168:183]
    s_add_u32 s54, s61, 8192
    s_waitcnt lgkmcnt(0)
    buffer_store_dwordx4 v[196:199], v20, s[36:39], s54 offen sc1
    v_add_u32 v8, 0xfffe0000, v8
    v_add_u32 v9, 0xfffe0000, v9
    v_add_u32 v10, 0xfffe0000, v10
    v_add_u32 v11, 0xfffe0000, v11
    v_add_u32 v12, 0xfffe0000, v12
    v_add_u32 v13, 0xfffe0000, v13
    v_add_u32 v14, 0xfffe0000, v14
    v_add_u32 v15, 0xfffe0000, v15
    s_waitcnt vmcnt(2)
    v_lshlrev_b32 v21, 4, v1
    v_add_u32 v21, s60, v21
    ds_write_b128 v21, v[24:27] offset:0
    ds_write_b128 v21, v[28:31] offset:1024
    ds_write_b128 v21, v[32:35] offset:16384
    ds_write_b128 v21, v[36:39] offset:17408
    ds_write_b128 v21, v[40:43] offset:32768
    ds_write_b128 v21, v[44:47] offset:33792
    s_waitcnt lgkmcnt(0)
    s_barrier
    s_cmp_lg_u32 s3, 0
    s_cbranch_scc1 L1_peek_Q
    s_mov_b32 s48, s24
    s_mov_b32 s49, s25
    s_mov_b32 s50, 256
    s_mov_b32 s51, 0x20000
    v_mov_b32 v22, 0
    s_mov_b32 exec_lo, 1
    s_mov_b32 exec_hi, 0
    buffer_load_dword v23, v22, s[48:51], 0 offen sc1
    s_mov_b64 exec, -1
L1_peek_Q:
    ds_read_b128 v[120:123], v8 offset:0
    ds_read_b128 v[124:127], v9 offset:0
    ds_read_b128 v[128:131], v10 offset:0
    ds_read_b128 v[132:135], v11 offset:0
    ds_read_b128 v[136:139], v12 offset:0
    ds_read_b128 v[140:143], v13 offset:0
    ds_read_b128 v[144:147], v14 offset:0
    ds_read_b128 v[148:151], v15 offset:0
    s_waitcnt lgkmcnt(7)
    v_mfma_f32_32x32x16_bf16 v[152:167], v[48:51], v[120:123], 0
    ds_read_b128 v[112:115], v8 offset:256
    s_waitcnt lgkmcnt(7)
    v_mfma_f32_32x32x16_bf16 v[152:167], v[52:55], v[124:127], v[152:167]
    ds_read_b128 v[116:119], v9 offset:256
    s_waitcnt lgkmcnt(7)
    v_mfma_f32_32x32x16_bf16 v[152:167], v[56:59], v[128:131], v[152:167]
    ds_read_b128 v[120:123], v10 offset:256
    s_waitcnt lgkmcnt(7)
    v_mfma_f32_32x32x16_bf16 v[152:167], v[60:63], v[132:135], v[152:167]
    ds_read_b128 v[124:127], v11 offset:256
    s_waitcnt lgkmcnt(7)
    v_mfma_f32_32x32x16_bf16 v[152:167], v[64:67], v[136:139], v[152:167]
    ds_read_b128 v[128:131], v12 offset:256
    s_waitcnt lgkmcnt(7)
    v_mfma_f32_32x32x16_bf16 v[152:167], v[68:71], v[140:143], v[152:167]
    ds_read_b128 v[132:135], v13 offset:256
    v_mul_f32 v168, s56, v168
    v_mul_f32 v169, s56, v169
    v_mul_f32 v170, s56, v170
    v_mul_f32 v171, s56, v171
    s_waitcnt lgkmcnt(7)
    v_mfma_f32_32x32x16_bf16 v[152:167], v[72:75], v[144:147], v[152:167]
    ds_read_b128 v[136:139], v14 offset:256
    v_mul_f32 v172, s56, v172
    v_mul_f32 v173, s56, v173
    v_mul_f32 v174, s56, v174
    v_mul_f32 v175, s56, v175
    s_waitcnt lgkmcnt(7)
    v_mfma_f32_32x32x16_bf16 v[152:167], v[76:79], v[148:151], v[152:167]
    ds_read_b128 v[140:143], v15 offset:256
    v_mul_f32 v176, s56, v176
    v_mul_f32 v177, s56, v177
    v_mul_f32 v178, s56, v178
    s_waitcnt lgkmcnt(7)
    v_mfma_f32_32x32x16_bf16 v[152:167], v[80:83], v[112:115], v[152:167]
    ds_read_b128 v[144:147], v8 offset:16384
    v_mul_f32 v179, s56, v179
    v_mul_f32 v180, s56, v180
    v_mul_f32 v181, s56, v181
    s_waitcnt lgkmcnt(7)
    v_mfma_f32_32x32x16_bf16 v[152:167], v[84:87], v[116:119], v[152:167]
    ds_read_b128 v[148:151], v9 offset:16384
    v_mul_f32 v182, s56, v182
    v_mul_f32 v183, s56, v183
    v_cvt_pk_bf16_f32 v184, v168, v169
    s_waitcnt lgkmcnt(7)
    v_mfma_f32_32x32x16_bf16 v[152:167], v[88:91], v[120:123], v[152:167]
    ds_read_b128 v[112:115], v10 offset:16384
    v_cvt_pk_bf16_f32 v185, v170, v171
    v_cvt_pk_bf16_f32 v186, v172, v173
    v_cvt_pk_bf16_f32 v187, v174, v175
    s_waitcnt lgkmcnt(7)
    v_mfma_f32_32x32x16_bf16 v[152:167], v[92:95], v[124:127], v[152:167]
    ds_read_b128 v[116:119], v11 offset:16384
    v_cvt_pk_bf16_f32 v188, v176, v177
    v_cvt_pk_bf16_f32 v189, v178, v179
    v_cvt_pk_bf16_f32 v190, v180, v181
    s_waitcnt lgkmcnt(7)
    v_mfma_f32_32x32x16_bf16 v[152:167], v[96:99], v[128:131], v[152:167]
    ds_read_b128 v[120:123], v12 offset:16384
    v_cvt_pk_bf16_f32 v191, v182, v183
    ds_write_b128 v17, v[184:187]
    ds_write_b128 v18, v[188:191]
    s_waitcnt lgkmcnt(9)
    v_mfma_f32_32x32x16_bf16 v[152:167], v[100:103], v[132:135], v[152:167]
    ds_read_b128 v[124:127], v13 offset:16384
    s_waitcnt lgkmcnt(1)
    ds_read_b128 v[192:195], v19
    ds_read_b128 v[196:199], v19 offset:1024
    v_mfma_f32_32x32x16_bf16 v[152:167], v[104:107], v[136:139], v[152:167]
    ds_read_b128 v[128:131], v14 offset:16384
    s_add_u32 s54, s61, 16384
    s_waitcnt lgkmcnt(2)
    buffer_store_dwordx4 v[192:195], v20, s[36:39], s54 offen sc1
    v_mfma_f32_32x32x16_bf16 v[152:167], v[108:111], v[140:143], v[152:167]
    ds_read_b128 v[132:135], v15 offset:16384
    s_add_u32 s54, s61, 24576
    s_waitcnt lgkmcnt(2)
    buffer_store_dwordx4 v[196:199], v20, s[36:39], s54 offen sc1
    v_mfma_f32_32x32x16_bf16 v[168:183], v[48:51], v[144:147], 0
    ds_read_b128 v[136:139], v8 offset:16640
    v_mfma_f32_32x32x16_bf16 v[168:183], v[52:55], v[148:151], v[168:183]
    ds_read_b128 v[140:143], v9 offset:16640
    v_mfma_f32_32x32x16_bf16 v[168:183], v[56:59], v[112:115], v[168:183]
    ds_read_b128 v[144:147], v10 offset:16640
    v_and_b32 v241, 31, v1
    v_lshrrev_b32 v242, 5, v1
    s_lshl_b32 s80, s3, 13
    s_add_u32 s80, s80, 73216
    v_bfe_u32 v243, v241, 2, 2
    v_xor_b32 v244, v242, v243
    v_lshlrev_b32 v245, 6, v241
    v_mfma_f32_32x32x16_bf16 v[168:183], v[60:63], v[116:119], v[168:183]
    ds_read_b128 v[148:151], v11 offset:16640
    v_add_u32 v246, s80, v245
    v_lshl_add_u32 v214, v244, 4, v246
    v_xor_b32 v244, 2, v244
    v_lshl_add_u32 v215, v244, 4, v246
    v_lshlrev_b32 v244, 4, v241
    v_add_u32 v244, 2048, v244
    v_lshl_add_u32 v245, v243, 4, v245
    v_mfma_f32_32x32x16_bf16 v[168:183], v[64:67], v[120:123], v[168:183]
    ds_read_b128 v[112:115], v12 offset:16640
    v_cmp_eq_u32 vcc, 1, v242
    v_bfe_u32 v243, v1, 2, 2
    v_lshl_add_u32 v243, v242, 2, v243
    v_cndmask_b32 v225, v244, v245, vcc
    v_lshlrev_b32 v243, 6, v243
    v_and_b32 v244, 1, v1
    v_mfma_f32_32x32x16_bf16 v[168:183], v[68:71], v[124:127], v[168:183]
    ds_read_b128 v[116:119], v13 offset:16640
    v_lshl_add_u32 v243, v244, 3, v243
    v_bfe_u32 v244, v1, 4, 1
    v_lshlrev_b32 v244, 1, v244
    v_bfe_u32 v245, v1, 1, 1
    v_or_b32 v244, v244, v245
    v_xor_b32 v244, v244, v242
    v_mul_f32 v152, s56, v152
    v_mul_f32 v153, s56, v153
    v_mul_f32 v154, s56, v154
    v_mul_f32 v155, s56, v155
    s_waitcnt lgkmcnt(7)
    v_mfma_f32_32x32x16_bf16 v[168:183], v[72:75], v[128:131], v[168:183]
    ds_read_b128 v[120:123], v14 offset:16640
    v_lshl_add_u32 v226, v244, 4, v243
    v_xor_b32 v244, 2, v244
    v_lshl_add_u32 v245, v244, 4, v243
    v_add_u32 v227, 512, v245
    v_and_b32 v243, 3, v1
    v_bfe_u32 v244, v1, 4, 2
    v_mul_f32 v156, s56, v156
    v_mul_f32 v157, s56, v157
    v_mul_f32 v158, s56, v158
    v_mul_f32 v159, s56, v159
    s_waitcnt lgkmcnt(7)
    v_mfma_f32_32x32x16_bf16 v[168:183], v[76:79], v[132:135], v[168:183]
    ds_read_b128 v[124:127], v15 offset:16640
    v_xor_b32 v243, v243, v244
    v_lshlrev_b32 v243, 4, v243
    s_lshl_b32 s52, s3, 6
    s_sub_u32 s53, s52, 512
    v_add_u32 v220, s53, v243
    v_and_b32 v243, 7, v1
    v_mul_f32 v160, s56, v160
    v_mul_f32 v161, s56, v161
    v_mul_f32 v162, s56, v162
    s_waitcnt lgkmcnt(7)
    v_mfma_f32_32x32x16_bf16 v[168:183], v[80:83], v[136:139], v[168:183]
    ds_read_b128 v[128:131], v8 offset:32768
    v_mul_u32_u24 v243, 544, v243
    v_lshl_add_u32 v243, v242, 5, v243
    s_add_u32 s52, s52, 138752
    v_add_u32 v221, s52, v243
    v_lshlrev_b32 v243, 2, v241
    v_add_u32 v222, 160512, v243
    v_mul_f32 v163, s56, v163
    v_mul_f32 v164, s56, v164
    v_mul_f32 v165, s56, v165
    s_waitcnt lgkmcnt(7)
    v_mfma_f32_32x32x16_bf16 v[168:183], v[84:87], v[140:143], v[168:183]
    ds_read_b128 v[132:135], v9 offset:32768
    v_lshrrev_b32 v243, 2, v1
    v_lshlrev_b32 v243, 2, v243
    v_add_u32 v240, 69120, v243
    v_and_b32 v241, 31, v1
    v_lshrrev_b32 v242, 5, v1
    v_mov_b32 v208, 1.0
    v_mul_f32 v166, s56, v166
    v_mul_f32 v167, s56, v167
    v_cvt_pk_bf16_f32 v184, v152, v153
    s_waitcnt lgkmcnt(7)
    v_mfma_f32_32x32x16_bf16 v[168:183], v[88:91], v[144:147], v[168:183]
    ds_read_b128 v[136:139], v10 offset:32768
    v_mov_b32 v209, 1.0
    v_mov_b32 v236, 0
    v_mov_b32 v237, 0
    v_mov_b32 v238, 0
    v_mov_b32 v239, 0
    s_mov_b32 s86, 0xff
    v_cvt_pk_bf16_f32 v185, v154, v155
    v_cvt_pk_bf16_f32 v186, v156, v157
    v_cvt_pk_bf16_f32 v187, v158, v159
    s_waitcnt lgkmcnt(7)
    v_mfma_f32_32x32x16_bf16 v[168:183], v[92:95], v[148:151], v[168:183]
    ds_read_b128 v[140:143], v11 offset:32768
    s_mov_b32 s87, 0xff
    v_lshlrev_b32 v243, 3, v242
    v_sub_u32 v243, v241, v243
    v_mov_b32 v245, 0x3f80
    v_mov_b32 v246, 0x3f800000
    v_and_b32 v244, 1, v243
    v_cvt_pk_bf16_f32 v188, v160, v161
    v_cvt_pk_bf16_f32 v189, v162, v163
    v_cvt_pk_bf16_f32 v190, v164, v165
    s_waitcnt lgkmcnt(7)
    v_mfma_f32_32x32x16_bf16 v[168:183], v[96:99], v[112:115], v[168:183]
    ds_read_b128 v[144:147], v12 offset:32768
    v_cmp_eq_u32 vcc, 1, v244
    v_lshrrev_b32 v247, 1, v243
    v_add_u32 v248, -8, v247
    v_cndmask_b32 v244, v245, v246, vcc
    v_cmp_eq_u32 s[64:65], 0, v247
    v_cmp_eq_u32 s[66:67], 1, v247
    v_cvt_pk_bf16_f32 v191, v166, v167
    ds_write_b128 v17, v[184:187]
    ds_write_b128 v18, v[188:191]
    s_waitcnt lgkmcnt(9)
    v_mfma_f32_32x32x16_bf16 v[168:183], v[100:103], v[116:119], v[168:183]
    ds_read_b128 v[148:151], v13 offset:32768
    s_nop 0
    v_cndmask_b32 v200, 0, v244, s[64:65]
    v_cndmask_b32 v201, 0, v244, s[66:67]
    v_cmp_eq_u32 s[64:65], 2, v247
    v_cmp_eq_u32 s[66:67], 3, v247
    s_nop 0
    s_waitcnt lgkmcnt(1)
    ds_read_b128 v[192:195], v19
    ds_read_b128 v[196:199], v19 offset:1024
    v_mfma_f32_32x32x16_bf16 v[168:183], v[104:107], v[120:123], v[168:183]
    ds_read_b128 v[112:115], v14 offset:32768
    v_cndmask_b32 v202, 0, v244, s[64:65]
    v_cndmask_b32 v203, 0, v244, s[66:67]
    v_cmp_eq_u32 s[64:65], 0, v248
    v_cmp_eq_u32 s[66:67], 1, v248
    s_nop 0
    v_cndmask_b32 v204, 0, v244, s[64:65]
    s_add_u32 s54, s61, 32768
    s_waitcnt lgkmcnt(2)
    buffer_store_dwordx4 v[192:195], v20, s[36:39], s54 offen sc1
    v_mfma_f32_32x32x16_bf16 v[168:183], v[108:111], v[124:127], v[168:183]
    ds_read_b128 v[116:119], v15 offset:32768
    v_cndmask_b32 v205, 0, v244, s[66:67]
    v_cmp_eq_u32 s[64:65], 2, v248
    v_cmp_eq_u32 s[66:67], 3, v248
    s_nop 0
    v_cndmask_b32 v206, 0, v244, s[64:65]
    v_cndmask_b32 v207, 0, v244, s[66:67]
    s_add_u32 s54, s61, 40960
    s_waitcnt lgkmcnt(2)
    buffer_store_dwordx4 v[196:199], v20, s[36:39], s54 offen sc1
    v_mfma_f32_32x32x16_bf16 v[152:167], v[48:51], v[128:131], 0
    ds_read_b128 v[120:123], v8 offset:33024
    v_mfma_f32_32x32x16_bf16 v[152:167], v[52:55], v[132:135], v[152:167]
    ds_read_b128 v[124:127], v9 offset:33024
    v_mfma_f32_32x32x16_bf16 v[152:167], v[56:59], v[136:139], v[152:167]
    ds_read_b128 v[128:131], v10 offset:33024
    v_mfma_f32_32x32x16_bf16 v[152:167], v[60:63], v[140:143], v[152:167]
    ds_read_b128 v[132:135], v11 offset:33024
    v_mfma_f32_32x32x16_bf16 v[152:167], v[64:67], v[144:147], v[152:167]
    ds_read_b128 v[136:139], v12 offset:33024
    v_mfma_f32_32x32x16_bf16 v[152:167], v[68:71], v[148:151], v[152:167]
    ds_read_b128 v[140:143], v13 offset:33024
    v_mul_f32 v168, s56, v168
    v_mul_f32 v169, s56, v169
    v_mul_f32 v170, s56, v170
    v_mul_f32 v171, s56, v171
    s_waitcnt lgkmcnt(7)
    v_mfma_f32_32x32x16_bf16 v[152:167], v[72:75], v[112:115], v[152:167]
    ds_read_b128 v[144:147], v14 offset:33024
    v_mul_f32 v172, s56, v172
    v_mul_f32 v173, s56, v173
    v_mul_f32 v174, s56, v174
    v_mul_f32 v175, s56, v175
    s_waitcnt lgkmcnt(7)
    v_mfma_f32_32x32x16_bf16 v[152:167], v[76:79], v[116:119], v[152:167]
    ds_read_b128 v[148:151], v15 offset:33024
    v_mul_f32 v176, s56, v176
    v_mul_f32 v177, s56, v177
    v_mul_f32 v178, s56, v178
    s_waitcnt lgkmcnt(7)
    v_mfma_f32_32x32x16_bf16 v[152:167], v[80:83], v[120:123], v[152:167]
    v_mul_f32 v179, s56, v179
    v_mul_f32 v180, s56, v180
    v_mul_f32 v181, s56, v181
    s_waitcnt lgkmcnt(6)
    v_mfma_f32_32x32x16_bf16 v[152:167], v[84:87], v[124:127], v[152:167]
    v_mul_f32 v182, s56, v182
    v_mul_f32 v183, s56, v183
    v_cvt_pk_bf16_f32 v184, v168, v169
    s_waitcnt lgkmcnt(5)
    v_mfma_f32_32x32x16_bf16 v[152:167], v[88:91], v[128:131], v[152:167]
    v_cvt_pk_bf16_f32 v185, v170, v171
    v_cvt_pk_bf16_f32 v186, v172, v173
    v_cvt_pk_bf16_f32 v187, v174, v175
    s_waitcnt lgkmcnt(4)
    v_mfma_f32_32x32x16_bf16 v[152:167], v[92:95], v[132:135], v[152:167]
    v_cvt_pk_bf16_f32 v188, v176, v177
    v_cvt_pk_bf16_f32 v189, v178, v179
    v_cvt_pk_bf16_f32 v190, v180, v181
    s_waitcnt lgkmcnt(3)
    v_mfma_f32_32x32x16_bf16 v[152:167], v[96:99], v[136:139], v[152:167]
    v_cvt_pk_bf16_f32 v191, v182, v183
    ds_write_b128 v17, v[184:187]
    ds_write_b128 v18, v[188:191]
    s_waitcnt lgkmcnt(4)
    v_mfma_f32_32x32x16_bf16 v[152:167], v[100:103], v[140:143], v[152:167]
    s_waitcnt lgkmcnt(0)
    ds_read_b128 v[192:195], v19
    ds_read_b128 v[196:199], v19 offset:1024
    v_mfma_f32_32x32x16_bf16 v[152:167], v[104:107], v[144:147], v[152:167]
    s_add_u32 s54, s61, 49152
    s_waitcnt lgkmcnt(1)
    buffer_store_dwordx4 v[192:195], v20, s[36:39], s54 offen sc1
    v_mfma_f32_32x32x16_bf16 v[152:167], v[108:111], v[148:151], v[152:167]
    s_add_u32 s54, s61, 57344
    s_waitcnt lgkmcnt(0)
    buffer_store_dwordx4 v[196:199], v20, s[36:39], s54 offen sc1
    s_nop 7
    s_nop 3
    v_mul_f32 v152, s56, v152
    v_mul_f32 v153, s56, v153
    v_mul_f32 v154, s56, v154
    v_mul_f32 v155, s56, v155
    v_mul_f32 v156, s56, v156
    v_mul_f32 v157, s56, v157
    v_mul_f32 v158, s56, v158
    v_mul_f32 v159, s56, v159
    v_mul_f32 v160, s56, v160
    v_mul_f32 v161, s56, v161
    v_mul_f32 v162, s56, v162
    v_mul_f32 v163, s56, v163
    v_mul_f32 v164, s56, v164
    v_mul_f32 v165, s56, v165
    v_mul_f32 v166, s56, v166
    v_mul_f32 v167, s56, v167
    v_cvt_pk_bf16_f32 v184, v152, v153
    v_cvt_pk_bf16_f32 v185, v154, v155
    v_cvt_pk_bf16_f32 v186, v156, v157
    v_cvt_pk_bf16_f32 v187, v158, v159
    v_cvt_pk_bf16_f32 v188, v160, v161
    v_cvt_pk_bf16_f32 v189, v162, v163
    v_cvt_pk_bf16_f32 v190, v164, v165
    v_cvt_pk_bf16_f32 v191, v166, v167
    ds_write_b128 v17, v[184:187]
    ds_write_b128 v18, v[188:191]
    s_waitcnt lgkmcnt(0)
    ds_read_b128 v[192:195], v19
    ds_read_b128 v[196:199], v19 offset:1024
    s_add_u32 s54, s61, 65536
    s_waitcnt lgkmcnt(1)
    buffer_store_dwordx4 v[192:195], v20, s[36:39], s54 offen sc1
    s_add_u32 s54, s61, 73728
    s_waitcnt lgkmcnt(0)
    buffer_store_dwordx4 v[196:199], v20, s[36:39], s54 offen sc1
    s_waitcnt lgkmcnt(0)
    s_barrier
    v_mov_b32 v36, 0
    v_mov_b32 v37, 0
    v_mov_b32 v38, 0
    v_mov_b32 v39, 0
    v_lshlrev_b32 v40, 4, v0
    v_add_u32 v41, 0x10000, v40
    ds_write_b128 v40, v[36:39] offset:0
    ds_write_b128 v40, v[36:39] offset:8192
    ds_write_b128 v40, v[36:39] offset:16384
    ds_write_b128 v40, v[36:39] offset:24576
    ds_write_b128 v40, v[36:39] offset:32768
    ds_write_b128 v40, v[36:39] offset:40960
    ds_write_b128 v40, v[36:39] offset:49152
    ds_write_b128 v40, v[36:39] offset:57344
    ds_write_b128 v41, v[36:39]
    s_cmp_eq_u32 s3, 0
    s_cbranch_scc0 1f
    v_add_u32 v41, 160512, v40
    s_mov_b32 exec_lo, -1
    s_mov_b32 exec_hi, 0xff
    ds_write_b128 v41, v[36:39]
    s_mov_b64 exec, -1
1:
    s_mov_b32 s84, 0x10000
    s_cmp_lg_u32 s3, 0
    s_cbranch_scc1 L1_peek2_Q
    s_waitcnt vmcnt(0)
    v_and_b32 v23, 0xffff, v23
    v_mov_b32 v22, 163824
    s_mov_b32 exec_lo, 1
    s_mov_b32 exec_hi, 0
    ds_write_b32 v22, v23
    s_mov_b64 exec, -1
L1_peek2_Q:
    s_waitcnt vmcnt(0) lgkmcnt(0)
    s_barrier
    v_mov_b32 v22, 163824
    ds_read_b32 v23, v22
    s_waitcnt lgkmcnt(0)
    v_readfirstlane_b32 s52, v23
    s_cmp_eq_u32 s52, 0x3c01
    s_cbranch_scc1 L_phase2_fast
    s_branch L_phase2
L1_gemm_R:
    s_mov_b32 s28, s18
    s_mov_b32 s29, s19
    s_mov_b32 s30, 131072
    s_mov_b32 s31, 0x20000
    s_mov_b32 s32, s4
    s_mov_b32 s33, s5
    s_mov_b32 s34, 5120000
    s_mov_b32 s35, 0x20000
    v_lshrrev_b32 v2, 2, v1
    v_lshlrev_b32 v2, 9, v2
    v_and_b32 v3, 3, v1
    v_lshl_add_u32 v2, v3, 4, v2
    s_lshl_b32 s52, s3, 6
    v_add_u32 v2, s52, v2
    v_lshrrev_b32 v5, 5, v1
    s_lshl_b32 s52, s3, 2
    v_and_b32 v6, 31, v1
    v_add_u32 v7, s52, v5
    v_and_b32 v16, 15, v7
    v_xor_b32 v16, v16, v6
    v_lshlrev_b32 v16, 4, v16
    v_lshl_add_u32 v3, v7, 9, v16
    v_add_u32 v7, s52, v5
    v_add_u32 v7, 2, v7
    v_and_b32 v16, 15, v7
    v_xor_b32 v16, v16, v6
    v_lshlrev_b32 v16, 4, v16
    v_lshl_add_u32 v4, v7, 9, v16
    s_mul_i32 s59, s58, 81920
    s_lshl_b32 s60, s3, 11
    s_lshl_b32 s62, s3, 14
    s_setprio 3
    s_add_u32 m0, s60, 131072
    s_add_u32 s54, s59, 0
    buffer_load_dwordx4 v3, s[32:35], s54 offen lds
    s_add_u32 m0, s60, 132096
    s_add_u32 s54, s59, 0
    buffer_load_dwordx4 v4, s[32:35], s54 offen lds
    s_add_u32 m0, s62, 0
    s_mov_b32 s54, 0
    buffer_load_dwordx4 v2, s[28:31], s54 offen lds
    s_add_u32 m0, s62, 1024
    s_mov_b32 s54, 8192
    buffer_load_dwordx4 v2, s[28:31], s54 offen lds
    s_add_u32 m0, s62, 2048
    s_mov_b32 s54, 16384
    buffer_load_dwordx4 v2, s[28:31], s54 offen lds
    s_add_u32 m0, s62, 3072
    s_mov_b32 s54, 24576
    buffer_load_dwordx4 v2, s[28:31], s54 offen lds
    s_add_u32 m0, s62, 4096
    s_mov_b32 s54, 32768
    buffer_load_dwordx4 v2, s[28:31], s54 offen lds
    s_add_u32 m0, s62, 5120
    s_mov_b32 s54, 40960
    buffer_load_dwordx4 v2, s[28:31], s54 offen lds
    s_add_u32 m0, s62, 6144
    s_mov_b32 s54, 49152
    buffer_load_dwordx4 v2, s[28:31], s54 offen lds
    s_add_u32 m0, s62, 7168
    s_mov_b32 s54, 57344
    buffer_load_dwordx4 v2, s[28:31], s54 offen lds
    s_setprio 0
    s_add_u32 s36, s20, 10485760
    s_addc_u32 s37, s21, 0
    s_mov_b32 s38, 5120000
    s_mov_b32 s39, 0x20000
    v_lshrrev_b32 v5, 5, v1
    v_bfe_u32 v6, v1, 2, 2
    v_lshl_add_u32 v6, v5, 3, v6
    v_lshlrev_b32 v6, 6, v6
    v_bfe_u32 v7, v1, 4, 1
    v_and_b32 v16, 3, v1
    v_lshl_add_u32 v7, v7, 2, v16
    v_and_b32 v16, 1, v7
    v_lshlrev_b32 v16, 5, v16
    v_lshrrev_b32 v7, 1, v7
    v_lshl_add_u32 v7, v7, 3, v16
    v_add_u32 v5, v6, v7
    s_lshl_b32 s53, s3, 14
    v_add_u32 v5, s53, v5
    v_and_b32 v6, 31, v1
    v_lshrrev_b32 v7, 5, v1
    v_and_b32 v16, 15, v6
    v_xor_b32 v7, v7, v16
    v_lshlrev_b32 v6, 9, v6
    v_add_u32 v6, 0x20000, v6
    v_xor_b32 v16, 0, v7
    v_lshl_add_u32 v8, v16, 4, v6
    v_xor_b32 v16, 2, v7
    v_lshl_add_u32 v9, v16, 4, v6
    v_xor_b32 v16, 4, v7
    v_lshl_add_u32 v10, v16, 4, v6
    v_xor_b32 v16, 6, v7
    v_lshl_add_u32 v11, v16, 4, v6
    v_xor_b32 v16, 8, v7
    v_lshl_add_u32 v12, v16, 4, v6
    v_xor_b32 v16, 10, v7
    v_lshl_add_u32 v13, v16, 4, v6
    v_xor_b32 v16, 12, v7
    v_lshl_add_u32 v14, v16, 4, v6
    v_xor_b32 v16, 14, v7
    v_lshl_add_u32 v15, v16, 4, v6
    v_and_b32 v6, 31, v1
    v_lshrrev_b32 v7, 5, v1
    s_mul_i32 s61, s58, 81920
    s_lshl_b32 s52, s3, 9
    v_lshrrev_b32 v17, 3, v6
    v_lshlrev_b32 v17, 12, v17
    v_lshl_add_u32 v17, v7, 8, v17
    v_and_b32 v16, 7, v6
    v_lshl_add_u32 v17, v16, 4, v17
    v_add_u32 v17, s52, v17
    s_mov_b32 s56, 0xbfb8aa3b
    s_waitcnt vmcnt(8)
    s_barrier
    ds_read_b128 v[112:115], v8 offset:0
    ds_read_b128 v[116:119], v9 offset:0
    ds_read_b128 v[120:123], v10 offset:0
    ds_read_b128 v[124:127], v11 offset:0
    ds_read_b128 v[128:131], v12 offset:0
    ds_read_b128 v[132:135], v13 offset:0
    s_waitcnt vmcnt(7)
    ds_read_b64_tr_b16 v[48:49], v5 offset:0
    ds_read_b64_tr_b16 v[50:51], v5 offset:256
    s_waitcnt vmcnt(6)
    ds_read_b64_tr_b16 v[52:53], v5 offset:1024
    ds_read_b64_tr_b16 v[54:55], v5 offset:1280
    s_add_u32 m0, s62, 8192
    s_mov_b32 s54, 65536
    buffer_load_dwordx4 v2, s[28:31], s54 offen lds
    s_waitcnt vmcnt(6)
    ds_read_b64_tr_b16 v[56:57], v5 offset:2048
    ds_read_b64_tr_b16 v[58:59], v5 offset:2304
    s_waitcnt lgkmcnt(4)
    v_mfma_f32_32x32x16_bf16 v[152:167], v[48:51], v[112:115], 0
    ds_read_b128 v[136:139], v14 offset:0
    s_add_u32 m0, s62, 9216
    s_mov_b32 s54, 73728
    buffer_load_dwordx4 v2, s[28:31], s54 offen lds
    s_waitcnt vmcnt(6)
    ds_read_b64_tr_b16 v[60:61], v5 offset:3072
    ds_read_b64_tr_b16 v[62:63], v5 offset:3328
    s_waitcnt lgkmcnt(5)
    v_mfma_f32_32x32x16_bf16 v[152:167], v[52:55], v[116:119], v[152:167]
    ds_read_b128 v[140:143], v15 offset:0
    s_add_u32 m0, s62, 10240
    s_mov_b32 s54, 81920
    buffer_load_dwordx4 v2, s[28:31], s54 offen lds
    s_waitcnt vmcnt(6)
    ds_read_b64_tr_b16 v[64:65], v5 offset:4096
    ds_read_b64_tr_b16 v[66:67], v5 offset:4352
    s_waitcnt lgkmcnt(6)
    v_mfma_f32_32x32x16_bf16 v[152:167], v[56:59], v[120:123], v[152:167]
    ds_read_b128 v[144:147], v8 offset:256
    s_add_u32 m0, s62, 11264
    s_mov_b32 s54, 90112
    buffer_load_dwordx4 v2, s[28:31], s54 offen lds
    s_waitcnt vmcnt(6)
    ds_read_b64_tr_b16 v[68:69], v5 offset:5120
    ds_read_b64_tr_b16 v[70:71], v5 offset:5376
    s_waitcnt lgkmcnt(6)
    v_mfma_f32_32x32x16_bf16 v[152:167], v[60:63], v[124:127], v[152:167]
    ds_read_b128 v[148:151], v9 offset:256
    s_add_u32 m0, s62, 12288
    s_mov_b32 s54, 98304
    buffer_load_dwordx4 v2, s[28:31], s54 offen lds
    s_waitcnt vmcnt(6)
    ds_read_b64_tr_b16 v[72:73], v5 offset:6144
    ds_read_b64_tr_b16 v[74:75], v5 offset:6400
    s_waitcnt lgkmcnt(6)
    v_mfma_f32_32x32x16_bf16 v[152:167], v[64:67], v[128:131], v[152:167]
    ds_read_b128 v[112:115], v10 offset:256
    s_add_u32 m0, s62, 13312
    s_mov_b32 s54, 106496
    buffer_load_dwordx4 v2, s[28:31], s54 offen lds
    s_waitcnt vmcnt(6)
    ds_read_b64_tr_b16 v[76:77], v5 offset:7168
    ds_read_b64_tr_b16 v[78:79], v5 offset:7424
    s_waitcnt lgkmcnt(6)
    v_mfma_f32_32x32x16_bf16 v[152:167], v[68:71], v[132:135], v[152:167]
    ds_read_b128 v[116:119], v11 offset:256
    s_add_u32 m0, s62, 14336
    s_mov_b32 s54, 114688
    buffer_load_dwordx4 v2, s[28:31], s54 offen lds
    s_waitcnt vmcnt(6)
    ds_read_b64_tr_b16 v[80:81], v5 offset:8192
    ds_read_b64_tr_b16 v[82:83], v5 offset:8448
    s_waitcnt lgkmcnt(6)
    v_mfma_f32_32x32x16_bf16 v[152:167], v[72:75], v[136:139], v[152:167]
    ds_read_b128 v[120:123], v12 offset:256
    s_add_u32 m0, s62, 15360
    s_mov_b32 s54, 122880
    buffer_load_dwordx4 v2, s[28:31], s54 offen lds
    s_waitcnt vmcnt(6)
    ds_read_b64_tr_b16 v[84:85], v5 offset:9216
    ds_read_b64_tr_b16 v[86:87], v5 offset:9472
    s_waitcnt lgkmcnt(6)
    v_mfma_f32_32x32x16_bf16 v[152:167], v[76:79], v[140:143], v[152:167]
    ds_read_b128 v[124:127], v13 offset:256
    s_add_u32 m0, s60, 147456
    s_add_u32 s54, s59, 16384
    buffer_load_dwordx4 v3, s[32:35], s54 offen lds
    s_add_u32 m0, s60, 148480
    s_add_u32 s54, s59, 16384
    buffer_load_dwordx4 v4, s[32:35], s54 offen lds
    s_waitcnt vmcnt(7)
    ds_read_b64_tr_b16 v[88:89], v5 offset:10240
    ds_read_b64_tr_b16 v[90:91], v5 offset:10496
    s_waitcnt lgkmcnt(6)
    v_mfma_f32_32x32x16_bf16 v[152:167], v[80:83], v[144:147], v[152:167]
    ds_read_b128 v[128:131], v14 offset:256
    s_add_u32 s54, s59, 32768
    buffer_load_dwordx4 v[24:27], v3, s[32:35], s54 offen
    buffer_load_dwordx4 v[28:31], v4, s[32:35], s54 offen
    s_waitcnt vmcnt(8)
    ds_read_b64_tr_b16 v[92:93], v5 offset:11264
    ds_read_b64_tr_b16 v[94:95], v5 offset:11520
    s_waitcnt lgkmcnt(6)
    v_mfma_f32_32x32x16_bf16 v[152:167], v[84:87], v[148:151], v[152:167]
    ds_read_b128 v[132:135], v15 offset:256
    s_add_u32 s54, s59, 49152
    buffer_load_dwordx4 v[32:35], v3, s[32:35], s54 offen
    buffer_load_dwordx4 v[36:39], v4, s[32:35], s54 offen
    s_waitcnt vmcnt(9)
    ds_read_b64_tr_b16 v[96:97], v5 offset:12288
    ds_read_b64_tr_b16 v[98:99], v5 offset:12544
    s_waitcnt lgkmcnt(6)
    v_mfma_f32_32x32x16_bf16 v[152:167], v[88:91], v[112:115], v[152:167]
    s_add_u32 s54, s59, 65536
    buffer_load_dwordx4 v[40:43], v3, s[32:35], s54 offen
    buffer_load_dwordx4 v[44:47], v4, s[32:35], s54 offen
    s_waitcnt vmcnt(10)
    ds_read_b64_tr_b16 v[100:101], v5 offset:13312
    ds_read_b64_tr_b16 v[102:103], v5 offset:13568
    s_waitcnt lgkmcnt(5)
    v_mfma_f32_32x32x16_bf16 v[152:167], v[92:95], v[116:119], v[152:167]
    s_waitcnt vmcnt(9)
    ds_read_b64_tr_b16 v[104:105], v5 offset:14336
    ds_read_b64_tr_b16 v[106:107], v5 offset:14592
    s_waitcnt lgkmcnt(4)
    v_mfma_f32_32x32x16_bf16 v[152:167], v[96:99], v[120:123], v[152:167]
    s_waitcnt vmcnt(8)
    ds_read_b64_tr_b16 v[108:109], v5 offset:15360
    ds_read_b64_tr_b16 v[110:111], v5 offset:15616
    s_waitcnt lgkmcnt(4)
    v_mfma_f32_32x32x16_bf16 v[152:167], v[100:103], v[124:127], v[152:167]
    s_waitcnt lgkmcnt(2)
    v_mfma_f32_32x32x16_bf16 v[152:167], v[104:107], v[128:131], v[152:167]
    s_waitcnt lgkmcnt(0)
    v_mfma_f32_32x32x16_bf16 v[152:167], v[108:111], v[132:135], v[152:167]
    s_waitcnt vmcnt(6)
    s_barrier
    ds_read_b128 v[136:139], v8 offset:16384
    ds_read_b128 v[140:143], v9 offset:16384
    ds_read_b128 v[144:147], v10 offset:16384
    ds_read_b128 v[148:151], v11 offset:16384
    ds_read_b128 v[112:115], v12 offset:16384
    ds_read_b128 v[116:119], v13 offset:16384
    s_waitcnt lgkmcnt(5)
    v_mfma_f32_32x32x16_bf16 v[168:183], v[48:51], v[136:139], 0
    ds_read_b128 v[120:123], v14 offset:16384
    ds_read_b128 v[124:127], v15 offset:16384
    ds_read_b128 v[128:131], v8 offset:16640
    s_waitcnt lgkmcnt(7)
    v_mfma_f32_32x32x16_bf16 v[168:183], v[52:55], v[140:143], v[168:183]
    ds_read_b128 v[132:135], v9 offset:16640
    s_waitcnt lgkmcnt(7)
    v_mfma_f32_32x32x16_bf16 v[168:183], v[56:59], v[144:147], v[168:183]
    ds_read_b128 v[136:139], v10 offset:16640
    s_waitcnt lgkmcnt(7)
    v_mfma_f32_32x32x16_bf16 v[168:183], v[60:63], v[148:151], v[168:183]
    ds_read_b128 v[140:143], v11 offset:16640
    s_waitcnt lgkmcnt(7)
    v_mfma_f32_32x32x16_bf16 v[168:183], v[64:67], v[112:115], v[168:183]
    ds_read_b128 v[144:147], v12 offset:16640
    s_waitcnt lgkmcnt(7)
    v_mfma_f32_32x32x16_bf16 v[168:183], v[68:71], v[116:119], v[168:183]
    ds_read_b128 v[148:151], v13 offset:16640
    v_mul_f32 v152, s56, v152
    v_mul_f32 v153, s56, v153
    v_mul_f32 v154, s56, v154
    s_waitcnt lgkmcnt(7)
    v_mfma_f32_32x32x16_bf16 v[168:183], v[72:75], v[120:123], v[168:183]
    ds_read_b128 v[112:115], v14 offset:16640
    v_mul_f32 v155, s56, v155
    v_mul_f32 v156, s56, v156
    v_mul_f32 v157, s56, v157
    s_waitcnt lgkmcnt(7)
    v_mfma_f32_32x32x16_bf16 v[168:183], v[76:79], v[124:127], v[168:183]
    ds_read_b128 v[116:119], v15 offset:16640
    v_mul_f32 v158, s56, v158
    v_mul_f32 v159, s56, v159
    v_mul_f32 v160, s56, v160
    s_waitcnt lgkmcnt(7)
    v_mfma_f32_32x32x16_bf16 v[168:183], v[80:83], v[128:131], v[168:183]
    v_mul_f32 v161, s56, v161
    v_mul_f32 v162, s56, v162
    v_mul_f32 v163, s56, v163
    s_waitcnt lgkmcnt(6)
    v_mfma_f32_32x32x16_bf16 v[168:183], v[84:87], v[132:135], v[168:183]
    v_mul_f32 v164, s56, v164
    v_mul_f32 v165, s56, v165
    v_mul_f32 v166, s56, v166
    s_waitcnt lgkmcnt(5)
    v_mfma_f32_32x32x16_bf16 v[168:183], v[88:91], v[136:139], v[168:183]
    v_mul_f32 v167, s56, v167
    v_cvt_pk_bf16_f32 v184, v152, v153
    s_waitcnt lgkmcnt(4)
    v_mfma_f32_32x32x16_bf16 v[168:183], v[92:95], v[140:143], v[168:183]
    v_cvt_pk_bf16_f32 v185, v154, v155
    v_cvt_pk_bf16_f32 v186, v156, v157
    s_waitcnt lgkmcnt(3)
    v_mfma_f32_32x32x16_bf16 v[168:183], v[96:99], v[144:147], v[168:183]
    v_cvt_pk_bf16_f32 v187, v158, v159
    v_cvt_pk_bf16_f32 v188, v160, v161
    s_waitcnt lgkmcnt(2)
    v_mfma_f32_32x32x16_bf16 v[168:183], v[100:103], v[148:151], v[168:183]
    v_cvt_pk_bf16_f32 v189, v162, v163
    v_cvt_pk_bf16_f32 v190, v164, v165
    s_waitcnt lgkmcnt(1)
    v_mfma_f32_32x32x16_bf16 v[168:183], v[104:107], v[112:115], v[168:183]
    v_cvt_pk_bf16_f32 v191, v166, v167
    s_add_u32 s54, s61, 0
    s_waitcnt lgkmcnt(0)
    v_mfma_f32_32x32x16_bf16 v[168:183], v[108:111], v[116:119], v[168:183]
    buffer_store_dwordx4 v[184:187], v17, s[36:39], s54 offen offset:0 sc1
    buffer_store_dwordx4 v[188:191], v17, s[36:39], s54 offen offset:128 sc1
    v_add_u32 v8, 0xfffe0000, v8
    v_add_u32 v9, 0xfffe0000, v9
    v_add_u32 v10, 0xfffe0000, v10
    v_add_u32 v11, 0xfffe0000, v11
    v_add_u32 v12, 0xfffe0000, v12
    v_add_u32 v13, 0xfffe0000, v13
    v_add_u32 v14, 0xfffe0000, v14
    v_add_u32 v15, 0xfffe0000, v15
    s_waitcnt vmcnt(2)
    v_lshlrev_b32 v21, 4, v1
    v_add_u32 v21, s60, v21
    ds_write_b128 v21, v[24:27] offset:0
    ds_write_b128 v21, v[28:31] offset:1024
    ds_write_b128 v21, v[32:35] offset:16384
    ds_write_b128 v21, v[36:39] offset:17408
    ds_write_b128 v21, v[40:43] offset:32768
    ds_write_b128 v21, v[44:47] offset:33792
    s_waitcnt lgkmcnt(0)
    s_barrier
    s_cmp_lg_u32 s3, 0
    s_cbranch_scc1 L1_peek_R
    s_mov_b32 s48, s24
    s_mov_b32 s49, s25
    s_mov_b32 s50, 256
    s_mov_b32 s51, 0x20000
    v_mov_b32 v22, 0
    s_mov_b32 exec_lo, 1
    s_mov_b32 exec_hi, 0
    buffer_load_dword v23, v22, s[48:51], 0 offen sc1
    s_mov_b64 exec, -1
L1_peek_R:
    ds_read_b128 v[120:123], v8 offset:0
    ds_read_b128 v[124:127], v9 offset:0
    ds_read_b128 v[128:131], v10 offset:0
    ds_read_b128 v[132:135], v11 offset:0
    ds_read_b128 v[136:139], v12 offset:0
    ds_read_b128 v[140:143], v13 offset:0
    ds_read_b128 v[144:147], v14 offset:0
    ds_read_b128 v[148:151], v15 offset:0
    s_waitcnt lgkmcnt(7)
    v_mfma_f32_32x32x16_bf16 v[152:167], v[48:51], v[120:123], 0
    ds_read_b128 v[112:115], v8 offset:256
    s_waitcnt lgkmcnt(7)
    v_mfma_f32_32x32x16_bf16 v[152:167], v[52:55], v[124:127], v[152:167]
    ds_read_b128 v[116:119], v9 offset:256
    s_waitcnt lgkmcnt(7)
    v_mfma_f32_32x32x16_bf16 v[152:167], v[56:59], v[128:131], v[152:167]
    ds_read_b128 v[120:123], v10 offset:256
    s_waitcnt lgkmcnt(7)
    v_mfma_f32_32x32x16_bf16 v[152:167], v[60:63], v[132:135], v[152:167]
    ds_read_b128 v[124:127], v11 offset:256
    s_waitcnt lgkmcnt(7)
    v_mfma_f32_32x32x16_bf16 v[152:167], v[64:67], v[136:139], v[152:167]
    ds_read_b128 v[128:131], v12 offset:256
    s_waitcnt lgkmcnt(7)
    v_mfma_f32_32x32x16_bf16 v[152:167], v[68:71], v[140:143], v[152:167]
    ds_read_b128 v[132:135], v13 offset:256
    v_mul_f32 v168, s56, v168
    v_mul_f32 v169, s56, v169
    v_mul_f32 v170, s56, v170
    s_waitcnt lgkmcnt(7)
    v_mfma_f32_32x32x16_bf16 v[152:167], v[72:75], v[144:147], v[152:167]
    ds_read_b128 v[136:139], v14 offset:256
    v_mul_f32 v171, s56, v171
    v_mul_f32 v172, s56, v172
    v_mul_f32 v173, s56, v173
    s_waitcnt lgkmcnt(7)
    v_mfma_f32_32x32x16_bf16 v[152:167], v[76:79], v[148:151], v[152:167]
    ds_read_b128 v[140:143], v15 offset:256
    v_mul_f32 v174, s56, v174
    v_mul_f32 v175, s56, v175
    v_mul_f32 v176, s56, v176
    s_waitcnt lgkmcnt(7)
    v_mfma_f32_32x32x16_bf16 v[152:167], v[80:83], v[112:115], v[152:167]
    ds_read_b128 v[144:147], v8 offset:16384
    v_mul_f32 v177, s56, v177
    v_mul_f32 v178, s56, v178
    v_mul_f32 v179, s56, v179
    s_waitcnt lgkmcnt(7)
    v_mfma_f32_32x32x16_bf16 v[152:167], v[84:87], v[116:119], v[152:167]
    ds_read_b128 v[148:151], v9 offset:16384
    v_mul_f32 v180, s56, v180
    v_mul_f32 v181, s56, v181
    v_mul_f32 v182, s56, v182
    s_waitcnt lgkmcnt(7)
    v_mfma_f32_32x32x16_bf16 v[152:167], v[88:91], v[120:123], v[152:167]
    ds_read_b128 v[112:115], v10 offset:16384
    v_mul_f32 v183, s56, v183
    v_cvt_pk_bf16_f32 v184, v168, v169
    s_waitcnt lgkmcnt(7)
    v_mfma_f32_32x32x16_bf16 v[152:167], v[92:95], v[124:127], v[152:167]
    ds_read_b128 v[116:119], v11 offset:16384
    v_cvt_pk_bf16_f32 v185, v170, v171
    v_cvt_pk_bf16_f32 v186, v172, v173
    s_waitcnt lgkmcnt(7)
    v_mfma_f32_32x32x16_bf16 v[152:167], v[96:99], v[128:131], v[152:167]
    ds_read_b128 v[120:123], v12 offset:16384
    v_cvt_pk_bf16_f32 v187, v174, v175
    v_cvt_pk_bf16_f32 v188, v176, v177
    s_waitcnt lgkmcnt(7)
    v_mfma_f32_32x32x16_bf16 v[152:167], v[100:103], v[132:135], v[152:167]
    ds_read_b128 v[124:127], v13 offset:16384
    v_cvt_pk_bf16_f32 v189, v178, v179
    v_cvt_pk_bf16_f32 v190, v180, v181
    s_waitcnt lgkmcnt(7)
    v_mfma_f32_32x32x16_bf16 v[152:167], v[104:107], v[136:139], v[152:167]
    ds_read_b128 v[128:131], v14 offset:16384
    v_cvt_pk_bf16_f32 v191, v182, v183
    s_add_u32 s54, s61, 16384
    s_waitcnt lgkmcnt(7)
    v_mfma_f32_32x32x16_bf16 v[152:167], v[108:111], v[140:143], v[152:167]
    ds_read_b128 v[132:135], v15 offset:16384
    buffer_store_dwordx4 v[184:187], v17, s[36:39], s54 offen offset:0 sc1
    buffer_store_dwordx4 v[188:191], v17, s[36:39], s54 offen offset:128 sc1
    s_waitcnt lgkmcnt(7)
    v_mfma_f32_32x32x16_bf16 v[168:183], v[48:51], v[144:147], 0
    ds_read_b128 v[136:139], v8 offset:16640
    s_waitcnt lgkmcnt(7)
    v_mfma_f32_32x32x16_bf16 v[168:183], v[52:55], v[148:151], v[168:183]
    ds_read_b128 v[140:143], v9 offset:16640
    s_waitcnt lgkmcnt(7)
    v_mfma_f32_32x32x16_bf16 v[168:183], v[56:59], v[112:115], v[168:183]
    ds_read_b128 v[144:147], v10 offset:16640
    v_and_b32 v241, 31, v1
    v_lshrrev_b32 v242, 5, v1
    s_lshl_b32 s80, s3, 13
    s_add_u32 s80, s80, 73216
    v_bfe_u32 v243, v241, 2, 2
    v_xor_b32 v244, v242, v243
    v_lshlrev_b32 v245, 6, v241
    s_waitcnt lgkmcnt(7)
    v_mfma_f32_32x32x16_bf16 v[168:183], v[60:63], v[116:119], v[168:183]
    ds_read_b128 v[148:151], v11 offset:16640
    v_add_u32 v246, s80, v245
    v_lshl_add_u32 v214, v244, 4, v246
    v_xor_b32 v244, 2, v244
    v_lshl_add_u32 v215, v244, 4, v246
    v_lshlrev_b32 v244, 4, v241
    v_add_u32 v244, 2048, v244
    v_lshl_add_u32 v245, v243, 4, v245
    s_waitcnt lgkmcnt(7)
    v_mfma_f32_32x32x16_bf16 v[168:183], v[64:67], v[120:123], v[168:183]
    ds_read_b128 v[112:115], v12 offset:16640
    v_cmp_eq_u32 vcc, 1, v242
    v_bfe_u32 v243, v1, 2, 2
    v_lshl_add_u32 v243, v242, 2, v243
    v_cndmask_b32 v225, v244, v245, vcc
    v_lshlrev_b32 v243, 6, v243
    v_and_b32 v244, 1, v1
    s_waitcnt lgkmcnt(7)
    v_mfma_f32_32x32x16_bf16 v[168:183], v[68:71], v[124:127], v[168:183]
    ds_read_b128 v[116:119], v13 offset:16640
    v_lshl_add_u32 v243, v244, 3, v243
    v_bfe_u32 v244, v1, 4, 1
    v_lshlrev_b32 v244, 1, v244
    v_bfe_u32 v245, v1, 1, 1
    v_or_b32 v244, v244, v245
    v_xor_b32 v244, v244, v242
    v_mul_f32 v152, s56, v152
    v_mul_f32 v153, s56, v153
    v_mul_f32 v154, s56, v154
    s_waitcnt lgkmcnt(7)
    v_mfma_f32_32x32x16_bf16 v[168:183], v[72:75], v[128:131], v[168:183]
    ds_read_b128 v[120:123], v14 offset:16640
    v_lshl_add_u32 v226, v244, 4, v243
    v_xor_b32 v244, 2, v244
    v_lshl_add_u32 v245, v244, 4, v243
    v_add_u32 v227, 512, v245
    v_and_b32 v243, 3, v1
    v_bfe_u32 v244, v1, 4, 2
    v_mul_f32 v155, s56, v155
    v_mul_f32 v156, s56, v156
    v_mul_f32 v157, s56, v157
    s_waitcnt lgkmcnt(7)
    v_mfma_f32_32x32x16_bf16 v[168:183], v[76:79], v[132:135], v[168:183]
    ds_read_b128 v[124:127], v15 offset:16640
    v_xor_b32 v243, v243, v244
    v_lshlrev_b32 v243, 4, v243
    s_lshl_b32 s52, s3, 6
    s_sub_u32 s53, s52, 512
    v_add_u32 v220, s53, v243
    v_and_b32 v243, 7, v1
    v_mul_f32 v158, s56, v158
    v_mul_f32 v159, s56, v159
    v_mul_f32 v160, s56, v160
    s_waitcnt lgkmcnt(7)
    v_mfma_f32_32x32x16_bf16 v[168:183], v[80:83], v[136:139], v[168:183]
    ds_read_b128 v[128:131], v8 offset:32768
    v_mul_u32_u24 v243, 544, v243
    v_lshl_add_u32 v243, v242, 5, v243
    s_add_u32 s52, s52, 138752
    v_add_u32 v221, s52, v243
    v_lshlrev_b32 v243, 2, v241
    v_add_u32 v222, 160512, v243
    v_mul_f32 v161, s56, v161
    v_mul_f32 v162, s56, v162
    v_mul_f32 v163, s56, v163
    s_waitcnt lgkmcnt(7)
    v_mfma_f32_32x32x16_bf16 v[168:183], v[84:87], v[140:143], v[168:183]
    ds_read_b128 v[132:135], v9 offset:32768
    v_lshrrev_b32 v243, 2, v1
    v_lshlrev_b32 v243, 2, v243
    v_add_u32 v240, 69120, v243
    v_and_b32 v241, 31, v1
    v_lshrrev_b32 v242, 5, v1
    v_mov_b32 v208, 1.0
    v_mul_f32 v164, s56, v164
    v_mul_f32 v165, s56, v165
    v_mul_f32 v166, s56, v166
    s_waitcnt lgkmcnt(7)
    v_mfma_f32_32x32x16_bf16 v[168:183], v[88:91], v[144:147], v[168:183]
    ds_read_b128 v[136:139], v10 offset:32768
    v_mov_b32 v209, 1.0
    v_mov_b32 v236, 0
    v_mov_b32 v237, 0
    v_mov_b32 v238, 0
    v_mov_b32 v239, 0
    s_mov_b32 s86, 0xff
    v_mul_f32 v167, s56, v167
    v_cvt_pk_bf16_f32 v184, v152, v153
    s_waitcnt lgkmcnt(7)
    v_mfma_f32_32x32x16_bf16 v[168:183], v[92:95], v[148:151], v[168:183]
    ds_read_b128 v[140:143], v11 offset:32768
    s_mov_b32 s87, 0xff
    v_lshlrev_b32 v243, 3, v242
    v_sub_u32 v243, v241, v243
    v_mov_b32 v245, 0x3f80
    v_mov_b32 v246, 0x3f800000
    v_and_b32 v244, 1, v243
    v_cvt_pk_bf16_f32 v185, v154, v155
    v_cvt_pk_bf16_f32 v186, v156, v157
    s_waitcnt lgkmcnt(7)
    v_mfma_f32_32x32x16_bf16 v[168:183], v[96:99], v[112:115], v[168:183]
    ds_read_b128 v[144:147], v12 offset:32768
    v_cmp_eq_u32 vcc, 1, v244
    v_lshrrev_b32 v247, 1, v243
    v_add_u32 v248, -8, v247
    v_cndmask_b32 v244, v245, v246, vcc
    v_cmp_eq_u32 s[64:65], 0, v247
    v_cmp_eq_u32 s[66:67], 1, v247
    v_cvt_pk_bf16_f32 v187, v158, v159
    v_cvt_pk_bf16_f32 v188, v160, v161
    s_waitcnt lgkmcnt(7)
    v_mfma_f32_32x32x16_bf16 v[168:183], v[100:103], v[116:119], v[168:183]
    ds_read_b128 v[148:151], v13 offset:32768
    s_nop 0
    v_cndmask_b32 v200, 0, v244, s[64:65]
    v_cndmask_b32 v201, 0, v244, s[66:67]
    v_cmp_eq_u32 s[64:65], 2, v247
    v_cmp_eq_u32 s[66:67], 3, v247
    s_nop 0
    v_cvt_pk_bf16_f32 v189, v162, v163
    v_cvt_pk_bf16_f32 v190, v164, v165
    s_waitcnt lgkmcnt(7)
    v_mfma_f32_32x32x16_bf16 v[168:183], v[104:107], v[120:123], v[168:183]
    ds_read_b128 v[112:115], v14 offset:32768
    v_cndmask_b32 v202, 0, v244, s[64:65]
    v_cndmask_b32 v203, 0, v244, s[66:67]
    v_cmp_eq_u32 s[64:65], 0, v248
    v_cmp_eq_u32 s[66:67], 1, v248
    s_nop 0
    v_cndmask_b32 v204, 0, v244, s[64:65]
    v_cvt_pk_bf16_f32 v191, v166, v167
    s_add_u32 s54, s61, 32768
    s_waitcnt lgkmcnt(7)
    v_mfma_f32_32x32x16_bf16 v[168:183], v[108:111], v[124:127], v[168:183]
    ds_read_b128 v[116:119], v15 offset:32768
    v_cndmask_b32 v205, 0, v244, s[66:67]
    v_cmp_eq_u32 s[64:65], 2, v248
    v_cmp_eq_u32 s[66:67], 3, v248
    s_nop 0
    v_cndmask_b32 v206, 0, v244, s[64:65]
    v_cndmask_b32 v207, 0, v244, s[66:67]
    buffer_store_dwordx4 v[184:187], v17, s[36:39], s54 offen offset:0 sc1
    buffer_store_dwordx4 v[188:191], v17, s[36:39], s54 offen offset:128 sc1
    s_waitcnt lgkmcnt(7)
    v_mfma_f32_32x32x16_bf16 v[152:167], v[48:51], v[128:131], 0
    ds_read_b128 v[120:123], v8 offset:33024
    s_waitcnt lgkmcnt(7)
    v_mfma_f32_32x32x16_bf16 v[152:167], v[52:55], v[132:135], v[152:167]
    ds_read_b128 v[124:127], v9 offset:33024
    s_waitcnt lgkmcnt(7)
    v_mfma_f32_32x32x16_bf16 v[152:167], v[56:59], v[136:139], v[152:167]
    ds_read_b128 v[128:131], v10 offset:33024
    s_waitcnt lgkmcnt(7)
    v_mfma_f32_32x32x16_bf16 v[152:167], v[60:63], v[140:143], v[152:167]
    ds_read_b128 v[132:135], v11 offset:33024
    s_waitcnt lgkmcnt(7)
    v_mfma_f32_32x32x16_bf16 v[152:167], v[64:67], v[144:147], v[152:167]
    ds_read_b128 v[136:139], v12 offset:33024
    s_waitcnt lgkmcnt(7)
    v_mfma_f32_32x32x16_bf16 v[152:167], v[68:71], v[148:151], v[152:167]
    ds_read_b128 v[140:143], v13 offset:33024
    v_mul_f32 v168, s56, v168
    v_mul_f32 v169, s56, v169
    v_mul_f32 v170, s56, v170
    s_waitcnt lgkmcnt(7)
    v_mfma_f32_32x32x16_bf16 v[152:167], v[72:75], v[112:115], v[152:167]
    ds_read_b128 v[144:147], v14 offset:33024
    v_mul_f32 v171, s56, v171
    v_mul_f32 v172, s56, v172
    v_mul_f32 v173, s56, v173
    s_waitcnt lgkmcnt(7)
    v_mfma_f32_32x32x16_bf16 v[152:167], v[76:79], v[116:119], v[152:167]
    ds_read_b128 v[148:151], v15 offset:33024
    v_mul_f32 v174, s56, v174
    v_mul_f32 v175, s56, v175
    v_mul_f32 v176, s56, v176
    s_waitcnt lgkmcnt(7)
    v_mfma_f32_32x32x16_bf16 v[152:167], v[80:83], v[120:123], v[152:167]
    v_mul_f32 v177, s56, v177
    v_mul_f32 v178, s56, v178
    v_mul_f32 v179, s56, v179
    s_waitcnt lgkmcnt(6)
    v_mfma_f32_32x32x16_bf16 v[152:167], v[84:87], v[124:127], v[152:167]
    v_mul_f32 v180, s56, v180
    v_mul_f32 v181, s56, v181
    v_mul_f32 v182, s56, v182
    s_waitcnt lgkmcnt(5)
    v_mfma_f32_32x32x16_bf16 v[152:167], v[88:91], v[128:131], v[152:167]
    v_mul_f32 v183, s56, v183
    v_cvt_pk_bf16_f32 v184, v168, v169
    s_waitcnt lgkmcnt(4)
    v_mfma_f32_32x32x16_bf16 v[152:167], v[92:95], v[132:135], v[152:167]
    v_cvt_pk_bf16_f32 v185, v170, v171
    v_cvt_pk_bf16_f32 v186, v172, v173
    s_waitcnt lgkmcnt(3)
    v_mfma_f32_32x32x16_bf16 v[152:167], v[96:99], v[136:139], v[152:167]
    v_cvt_pk_bf16_f32 v187, v174, v175
    v_cvt_pk_bf16_f32 v188, v176, v177
    s_waitcnt lgkmcnt(2)
    v_mfma_f32_32x32x16_bf16 v[152:167], v[100:103], v[140:143], v[152:167]
    v_cvt_pk_bf16_f32 v189, v178, v179
    v_cvt_pk_bf16_f32 v190, v180, v181
    s_waitcnt lgkmcnt(1)
    v_mfma_f32_32x32x16_bf16 v[152:167], v[104:107], v[144:147], v[152:167]
    v_cvt_pk_bf16_f32 v191, v182, v183
    s_add_u32 s54, s61, 49152
    s_waitcnt lgkmcnt(0)
    v_mfma_f32_32x32x16_bf16 v[152:167], v[108:111], v[148:151], v[152:167]
    buffer_store_dwordx4 v[184:187], v17, s[36:39], s54 offen offset:0 sc1
    buffer_store_dwordx4 v[188:191], v17, s[36:39], s54 offen offset:128 sc1
    s_nop 7
    s_nop 3
    v_mul_f32 v152, s56, v152
    v_mul_f32 v153, s56, v153
    v_mul_f32 v154, s56, v154
    v_mul_f32 v155, s56, v155
    v_mul_f32 v156, s56, v156
    v_mul_f32 v157, s56, v157
    v_mul_f32 v158, s56, v158
    v_mul_f32 v159, s56, v159
    v_mul_f32 v160, s56, v160
    v_mul_f32 v161, s56, v161
    v_mul_f32 v162, s56, v162
    v_mul_f32 v163, s56, v163
    v_mul_f32 v164, s56, v164
    v_mul_f32 v165, s56, v165
    v_mul_f32 v166, s56, v166
    v_mul_f32 v167, s56, v167
    v_cvt_pk_bf16_f32 v184, v152, v153
    v_cvt_pk_bf16_f32 v185, v154, v155
    v_cvt_pk_bf16_f32 v186, v156, v157
    v_cvt_pk_bf16_f32 v187, v158, v159
    v_cvt_pk_bf16_f32 v188, v160, v161
    v_cvt_pk_bf16_f32 v189, v162, v163
    v_cvt_pk_bf16_f32 v190, v164, v165
    v_cvt_pk_bf16_f32 v191, v166, v167
    s_add_u32 s54, s61, 65536
    buffer_store_dwordx4 v[184:187], v17, s[36:39], s54 offen offset:0 sc1
    buffer_store_dwordx4 v[188:191], v17, s[36:39], s54 offen offset:128 sc1
    s_waitcnt lgkmcnt(0)
    s_barrier
    v_mov_b32 v36, 0
    v_mov_b32 v37, 0
    v_mov_b32 v38, 0
    v_mov_b32 v39, 0
    v_lshlrev_b32 v40, 4, v0
    v_add_u32 v41, 0x10000, v40
    ds_write_b128 v40, v[36:39] offset:0
    ds_write_b128 v40, v[36:39] offset:8192
    ds_write_b128 v40, v[36:39] offset:16384
    ds_write_b128 v40, v[36:39] offset:24576
    ds_write_b128 v40, v[36:39] offset:32768
    ds_write_b128 v40, v[36:39] offset:40960
    ds_write_b128 v40, v[36:39] offset:49152
    ds_write_b128 v40, v[36:39] offset:57344
    ds_write_b128 v41, v[36:39]
    s_cmp_eq_u32 s3, 0
    s_cbranch_scc0 1f
    v_add_u32 v41, 160512, v40
    s_mov_b32 exec_lo, -1
    s_mov_b32 exec_hi, 0xff
    ds_write_b128 v41, v[36:39]
    s_mov_b64 exec, -1
1:
    s_mov_b32 s84, 0x10000
    s_cmp_lg_u32 s3, 0
    s_cbranch_scc1 L1_peek2_R
    s_waitcnt vmcnt(0)
    v_and_b32 v23, 0xffff, v23
    v_mov_b32 v22, 163824
    s_mov_b32 exec_lo, 1
    s_mov_b32 exec_hi, 0
    ds_write_b32 v22, v23
    s_mov_b64 exec, -1
L1_peek2_R:
    s_waitcnt vmcnt(0) lgkmcnt(0)
    s_barrier
    v_mov_b32 v22, 163824
    ds_read_b32 v23, v22
    s_waitcnt lgkmcnt(0)
    v_readfirstlane_b32 s52, v23
    s_cmp_eq_u32 s52, 0x3c01
    s_cbranch_scc1 L_phase2_fast
    s_branch L_phase2
L1_sort:
    s_sub_u32 s58, s2, 190
    s_mov_b32 s28, s12
    s_mov_b32 s29, s13
    s_mov_b32 s30, 640000
    s_mov_b32 s31, 0x20000
    s_mul_i32 s59, s58, 10668
    s_mul_i32 s60, s58, 21336
    v_lshlrev_b32 v2, 2, v0
    s_setprio 3
    s_add_u32 s54, s59, 0
    buffer_load_dword v8, v2, s[28:31], s54 offen
    s_add_u32 s54, s59, 2048
    buffer_load_dword v9, v2, s[28:31], s54 offen
    s_add_u32 s54, s59, 4096
    buffer_load_dword v10, v2, s[28:31], s54 offen
    s_add_u32 s54, s59, 6144
    buffer_load_dword v11, v2, s[28:31], s54 offen
    s_add_u32 s54, s59, 8192
    buffer_load_dword v12, v2, s[28:31], s54 offen
    s_add_u32 s54, s59, 10240
    buffer_load_dword v13, v2, s[28:31], s54 offen
    s_setprio 0
    s_mov_b32 s32, s10
    s_mov_b32 s33, s11
    s_mov_b32 s34, 640000
    s_mov_b32 s35, 0x20000
    s_add_u32 s54, s59, 0
    buffer_load_dword v14, v2, s[32:35], s54 offen
    s_add_u32 s54, s59, 2048
    buffer_load_dword v15, v2, s[32:35], s54 offen
    s_add_u32 s54, s59, 4096
    buffer_load_dword v16, v2, s[32:35], s54 offen
    s_add_u32 s54, s59, 6144
    buffer_load_dword v17, v2, s[32:35], s54 offen
    s_add_u32 s54, s59, 8192
    buffer_load_dword v18, v2, s[32:35], s54 offen
    s_add_u32 s54, s59, 10240
    buffer_load_dword v19, v2, s[32:35], s54 offen
    s_mov_b32 s40, s6
    s_mov_b32 s41, s7
    s_mov_b32 s42, 60000
    s_mov_b32 s43, 0x20000
    v_lshlrev_b32 v4, 4, v1
    s_lshl_b32 s52, s3, 10
    s_add_u32 s52, s52, 0
    s_mov_b32 m0, s52
    s_nop 0
    buffer_load_dwordx4 v4, s[40:43], s52 offen lds
    s_lshl_b32 s52, s3, 10
    s_add_u32 s52, s52, 8192
    s_mov_b32 m0, s52
    s_nop 0
    buffer_load_dwordx4 v4, s[40:43], s52 offen lds
    s_lshl_b32 s52, s3, 10
    s_add_u32 s52, s52, 16384
    s_mov_b32 m0, s52
    s_nop 0
    buffer_load_dwordx4 v4, s[40:43], s52 offen lds
    s_lshl_b32 s52, s3, 10
    s_add_u32 s52, s52, 24576
    s_mov_b32 m0, s52
    s_nop 0
    buffer_load_dwordx4 v4, s[40:43], s52 offen lds
    s_lshl_b32 s52, s3, 10
    s_add_u32 s52, s52, 32768
    s_mov_b32 m0, s52
    s_nop 0
    buffer_load_dwordx4 v4, s[40:43], s52 offen lds
    s_lshl_b32 s52, s3, 10
    s_add_u32 s52, s52, 40960
    s_mov_b32 m0, s52
    s_nop 0
    buffer_load_dwordx4 v4, s[40:43], s52 offen lds
    s_lshl_b32 s52, s3, 10
    s_add_u32 s52, s52, 49152
    s_mov_b32 m0, s52
    s_nop 0
    buffer_load_dwordx4 v4, s[40:43], s52 offen lds
    s_lshl_b32 s52, s3, 10
    s_add_u32 s52, s52, 57344
    s_mov_b32 m0, s52
    s_nop 0
    buffer_load_dwordx4 v4, s[40:43], s52 offen lds
    s_mov_b32 s36, s8
    s_mov_b32 s37, s9
    s_mov_b32 s38, 1280000
    s_mov_b32 s39, 0x20000
    v_lshlrev_b32 v3, 3, v0
    s_add_u32 s54, s60, 0
    buffer_load_dwordx2 v[20:21], v3, s[36:39], s54 offen
    s_add_u32 s54, s60, 4096
    buffer_load_dwordx2 v[22:23], v3, s[36:39], s54 offen
    s_add_u32 s54, s60, 8192
    buffer_load_dwordx2 v[24:25], v3, s[36:39], s54 offen
    s_add_u32 s54, s60, 12288
    buffer_load_dwordx2 v[26:27], v3, s[36:39], s54 offen
    s_add_u32 s54, s60, 16384
    buffer_load_dwordx2 v[28:29], v3, s[36:39], s54 offen
    s_add_u32 s54, s60, 20480
    buffer_load_dwordx2 v[30:31], v3, s[36:39], s54 offen
    s_mov_b32 s44, s20
    s_mov_b32 s45, s21
    s_mov_b32 s46, 21168128
    s_mov_b32 s47, 0x20000
    v_mov_b32 v76, 0
    v_mov_b32 v77, 0
    v_mov_b32 v78, 0
    v_mov_b32 v79, 0
    v_lshlrev_b32 v5, 4, v0
    v_add_u32 v5, 65536, v5
    s_cmp_ge_u32 s3, 5
    s_cbranch_scc1 L1_sort_z
    ds_write_b128 v5, v[76:79]
L1_sort_z:
    v_mov_b32 v6, 1
    s_mul_i32 s52, s58, 2667
    s_sub_u32 s52, 160000, s52
    s_min_u32 s52, s52, 2667
    s_sub_u32 s52, s52, 2560
    v_cmp_gt_u32 s[62:63], s52, v0
    s_waitcnt lgkmcnt(0)
    s_barrier
    s_waitcnt vmcnt(20)
    v_lshrrev_b32 v76, 3, v8
    v_lshlrev_b32 v62, 2, v76
    v_add_u32 v62, 65536, v62
    ds_add_rtn_u32 v68, v62, v6
    v_lshrrev_b32 v76, 3, v9
    v_lshlrev_b32 v63, 2, v76
    v_add_u32 v63, 65536, v63
    ds_add_rtn_u32 v69, v63, v6
    v_lshrrev_b32 v76, 3, v10
    v_lshlrev_b32 v64, 2, v76
    v_add_u32 v64, 65536, v64
    ds_add_rtn_u32 v70, v64, v6
    v_lshrrev_b32 v76, 3, v11
    v_lshlrev_b32 v65, 2, v76
    v_add_u32 v65, 65536, v65
    ds_add_rtn_u32 v71, v65, v6
    v_lshrrev_b32 v76, 3, v12
    v_lshlrev_b32 v66, 2, v76
    v_add_u32 v66, 65536, v66
    ds_add_rtn_u32 v72, v66, v6
    s_mov_b64 exec, s[62:63]
    s_cbranch_execz L1_sort_a
    v_lshrrev_b32 v76, 3, v13
    v_lshlrev_b32 v67, 2, v76
    v_add_u32 v67, 65536, v67
    ds_add_rtn_u32 v73, v67, v6
L1_sort_a:
    s_mov_b64 exec, -1
    v_and_b32 v120, 31, v1
    v_lshrrev_b32 v121, 5, v1
    s_lshl_b32 s80, s3, 13
    s_add_u32 s80, s80, 73216
    v_bfe_u32 v122, v120, 2, 2
    v_xor_b32 v123, v121, v122
    v_lshlrev_b32 v124, 6, v120
    v_add_u32 v125, s80, v124
    v_lshl_add_u32 v214, v123, 4, v125
    v_xor_b32 v123, 2, v123
    v_lshl_add_u32 v215, v123, 4, v125
    v_lshlrev_b32 v123, 4, v120
    v_add_u32 v123, 2048, v123
    v_lshl_add_u32 v124, v122, 4, v124
    v_cmp_eq_u32 vcc, 1, v121
    v_bfe_u32 v122, v1, 2, 2
    v_lshl_add_u32 v122, v121, 2, v122
    v_cndmask_b32 v225, v123, v124, vcc
    v_lshlrev_b32 v122, 6, v122
    v_and_b32 v123, 1, v1
    v_lshl_add_u32 v122, v123, 3, v122
    v_bfe_u32 v123, v1, 4, 1
    v_lshlrev_b32 v123, 1, v123
    v_bfe_u32 v124, v1, 1, 1
    v_or_b32 v123, v123, v124
    v_xor_b32 v123, v123, v121
    v_lshl_add_u32 v226, v123, 4, v122
    v_xor_b32 v123, 2, v123
    v_lshl_add_u32 v124, v123, 4, v122
    v_add_u32 v227, 512, v124
    v_and_b32 v122, 3, v1
    v_bfe_u32 v123, v1, 4, 2
    v_xor_b32 v122, v122, v123
    v_lshlrev_b32 v122, 4, v122
    s_lshl_b32 s52, s3, 6
    s_sub_u32 s53, s52, 512
    v_add_u32 v220, s53, v122
    v_and_b32 v122, 7, v1
    v_mul_u32_u24 v122, 544, v122
    v_lshl_add_u32 v122, v121, 5, v122
    s_add_u32 s52, s52, 138752
    v_add_u32 v221, s52, v122
    v_lshlrev_b32 v122, 2, v120
    v_add_u32 v222, 160512, v122
    v_lshrrev_b32 v122, 2, v1
    v_lshlrev_b32 v122, 2, v122
    v_add_u32 v240, 69120, v122
    v_and_b32 v120, 31, v1
    v_lshrrev_b32 v121, 5, v1
    v_mov_b32 v208, 1.0
    v_mov_b32 v209, 1.0
    v_mov_b32 v236, 0
    v_mov_b32 v237, 0
    v_mov_b32 v238, 0
    v_mov_b32 v239, 0
    s_mov_b32 s86, 0xff
    s_mov_b32 s87, 0xff
    v_lshlrev_b32 v122, 3, v121
    v_sub_u32 v122, v120, v122
    v_mov_b32 v124, 0x3f80
    v_mov_b32 v125, 0x3f800000
    v_and_b32 v123, 1, v122
    v_cmp_eq_u32 vcc, 1, v123
    v_lshrrev_b32 v126, 1, v122
    v_add_u32 v127, -8, v126
    v_cndmask_b32 v123, v124, v125, vcc
    v_cmp_eq_u32 s[64:65], 0, v126
    v_cmp_eq_u32 s[66:67], 1, v126
    s_nop 0
    v_cndmask_b32 v200, 0, v123, s[64:65]
    v_cndmask_b32 v201, 0, v123, s[66:67]
    v_cmp_eq_u32 s[64:65], 2, v126
    v_cmp_eq_u32 s[66:67], 3, v126
    s_nop 0
    v_cndmask_b32 v202, 0, v123, s[64:65]
    v_cndmask_b32 v203, 0, v123, s[66:67]
    v_cmp_eq_u32 s[64:65], 0, v127
    v_cmp_eq_u32 s[66:67], 1, v127
    s_nop 0
    v_cndmask_b32 v204, 0, v123, s[64:65]
    v_cndmask_b32 v205, 0, v123, s[66:67]
    v_cmp_eq_u32 s[64:65], 2, v127
    v_cmp_eq_u32 s[66:67], 3, v127
    s_nop 0
    v_cndmask_b32 v206, 0, v123, s[64:65]
    v_cndmask_b32 v207, 0, v123, s[66:67]
    s_waitcnt vmcnt(6)
    s_waitcnt lgkmcnt(0)
    s_barrier
    s_cmp_lg_u32 s3, 0
    s_cbranch_scc1 L1_sort_s1
    v_mul_u32_u24 v7, 80, v1
    v_add_u32 v7, 65536, v7
    ds_read_b128 v[96:99], v7 offset:0
    ds_read_b128 v[100:103], v7 offset:16
    ds_read_b128 v[104:107], v7 offset:32
    ds_read_b128 v[108:111], v7 offset:48
    ds_read_b128 v[112:115], v7 offset:64
    s_waitcnt lgkmcnt(0)
    v_mov_b32 v76, v96
    v_mov_b32 v96, 0
    v_add_u32 v77, v76, v97
    v_mov_b32 v97, v76
    v_mov_b32 v76, v77
    v_add_u32 v77, v76, v98
    v_mov_b32 v98, v76
    v_mov_b32 v76, v77
    v_add_u32 v77, v76, v99
    v_mov_b32 v99, v76
    v_mov_b32 v76, v77
    v_add_u32 v77, v76, v100
    v_mov_b32 v100, v76
    v_mov_b32 v76, v77
    v_add_u32 v77, v76, v101
    v_mov_b32 v101, v76
    v_mov_b32 v76, v77
    v_add_u32 v77, v76, v102
    v_mov_b32 v102, v76
    v_mov_b32 v76, v77
    v_add_u32 v77, v76, v103
    v_mov_b32 v103, v76
    v_mov_b32 v76, v77
    v_add_u32 v77, v76, v104
    v_mov_b32 v104, v76
    v_mov_b32 v76, v77
    v_add_u32 v77, v76, v105
    v_mov_b32 v105, v76
    v_mov_b32 v76, v77
    v_add_u32 v77, v76, v106
    v_mov_b32 v106, v76
    v_mov_b32 v76, v77
    v_add_u32 v77, v76, v107
    v_mov_b32 v107, v76
    v_mov_b32 v76, v77
    v_add_u32 v77, v76, v108
    v_mov_b32 v108, v76
    v_mov_b32 v76, v77
    v_add_u32 v77, v76, v109
    v_mov_b32 v109, v76
    v_mov_b32 v76, v77
    v_add_u32 v77, v76, v110
    v_mov_b32 v110, v76
    v_mov_b32 v76, v77
    v_add_u32 v77, v76, v111
    v_mov_b32 v111, v76
    v_mov_b32 v76, v77
    v_add_u32 v77, v76, v112
    v_mov_b32 v112, v76
    v_mov_b32 v76, v77
    v_add_u32 v77, v76, v113
    v_mov_b32 v113, v76
    v_mov_b32 v76, v77
    v_add_u32 v77, v76, v114
    v_mov_b32 v114, v76
    v_mov_b32 v76, v77
    v_add_u32 v77, v76, v115
    v_mov_b32 v115, v76
    v_mov_b32 v76, v77
    v_mov_b32 v78, v76
    s_nop 1
    v_add_u32_dpp v78, v78, v78 row_shr:1 row_mask:0xf bank_mask:0xf
    s_nop 1
    v_add_u32_dpp v78, v78, v78 row_shr:2 row_mask:0xf bank_mask:0xf
    s_nop 1
    v_add_u32_dpp v78, v78, v78 row_shr:4 row_mask:0xf bank_mask:0xf
    s_nop 1
    v_add_u32_dpp v78, v78, v78 row_shr:8 row_mask:0xf bank_mask:0xf
    s_nop 1
    v_add_u32_dpp v78, v78, v78 row_bcast:15 row_mask:0xa bank_mask:0xf
    s_nop 1
    v_add_u32_dpp v78, v78, v78 row_bcast:31 row_mask:0xc bank_mask:0xf
    v_sub_u32 v78, v78, v76
    v_add_u32 v96, v96, v78
    v_add_u32 v97, v97, v78
    v_add_u32 v98, v98, v78
    v_add_u32 v99, v99, v78
    v_add_u32 v100, v100, v78
    v_add_u32 v101, v101, v78
    v_add_u32 v102, v102, v78
    v_add_u32 v103, v103, v78
    v_add_u32 v104, v104, v78
    v_add_u32 v105, v105, v78
    v_add_u32 v106, v106, v78
    v_add_u32 v107, v107, v78
    v_add_u32 v108, v108, v78
    v_add_u32 v109, v109, v78
    v_add_u32 v110, v110, v78
    v_add_u32 v111, v111, v78
    v_add_u32 v112, v112, v78
    v_add_u32 v113, v113, v78
    v_add_u32 v114, v114, v78
    v_add_u32 v115, v115, v78
    ds_write_b128 v7, v[96:99] offset:0
    ds_write_b128 v7, v[100:103] offset:16
    ds_write_b128 v7, v[104:107] offset:32
    ds_write_b128 v7, v[108:111] offset:48
    ds_write_b128 v7, v[112:115] offset:64
L1_sort_s1:
    s_mov_b32 s55, 0xffff0000
    s_waitcnt lgkmcnt(0)
    v_mov_b32 v7, 0
    v_mul_u32_u24 v80, 6, v8
    v_and_b32 v80, -4, v80
    ds_read2_b32 v[96:97], v80 offset0:0 offset1:1
    v_mul_u32_u24 v80, 6, v14
    v_and_b32 v80, -4, v80
    ds_read2_b32 v[98:99], v80 offset0:0 offset1:1
    v_mul_u32_u24 v80, 6, v9
    v_and_b32 v80, -4, v80
    ds_read2_b32 v[100:101], v80 offset0:0 offset1:1
    v_mul_u32_u24 v80, 6, v15
    v_and_b32 v80, -4, v80
    ds_read2_b32 v[102:103], v80 offset0:0 offset1:1
    v_mul_u32_u24 v80, 6, v10
    v_and_b32 v80, -4, v80
    ds_read2_b32 v[104:105], v80 offset0:0 offset1:1
    v_mul_u32_u24 v80, 6, v16
    v_and_b32 v80, -4, v80
    ds_read2_b32 v[106:107], v80 offset0:0 offset1:1
    v_mul_u32_u24 v80, 6, v11
    v_and_b32 v80, -4, v80
    ds_read2_b32 v[108:109], v80 offset0:0 offset1:1
    v_mul_u32_u24 v80, 6, v17
    v_and_b32 v80, -4, v80
    ds_read2_b32 v[110:111], v80 offset0:0 offset1:1
    v_mul_u32_u24 v80, 6, v12
    v_and_b32 v80, -4, v80
    ds_read2_b32 v[112:113], v80 offset0:0 offset1:1
    v_mul_u32_u24 v80, 6, v18
    v_and_b32 v80, -4, v80
    ds_read2_b32 v[114:115], v80 offset0:0 offset1:1
    v_mul_u32_u24 v80, 6, v13
    v_and_b32 v80, -4, v80
    ds_read2_b32 v[116:117], v80 offset0:0 offset1:1
    v_mul_u32_u24 v80, 6, v19
    v_and_b32 v80, -4, v80
    ds_read2_b32 v[118:119], v80 offset0:0 offset1:1
    s_waitcnt vmcnt(0)
    v_and_b32 v81, 7, v8
    v_lshl_or_b32 v56, v81, 14, v14
    v_lshrrev_b32 v81, 3, v8
    v_lshl_or_b32 v56, v81, 17, v56
    v_and_b32 v82, 1, v8
    v_lshlrev_b32 v82, 4, v82
    v_and_b32 v83, 1, v14
    v_lshlrev_b32 v83, 4, v83
    s_waitcnt lgkmcnt(0)
    v_alignbit_b32 v96, v97, v96, v82
    v_lshrrev_b32 v97, v82, v97
    v_alignbit_b32 v98, v99, v98, v83
    v_lshrrev_b32 v99, v83, v99
    v_lshlrev_b32 v84, 16, v96
    v_lshlrev_b32 v85, 16, v98
    v_sub_f32 v84, v84, v85
    v_and_b32 v85, s55, v96
    v_and_b32 v86, s55, v98
    v_sub_f32 v85, v85, v86
    v_lshlrev_b32 v86, 16, v97
    v_lshlrev_b32 v87, 16, v99
    v_sub_f32 v86, v86, v87
    v_cvt_pk_bf16_f32 v88, v84, v85
    v_cvt_pk_bf16_f32 v89, v86, v7
    v_lshlrev_b32 v84, 16, v88
    v_and_b32 v85, s55, v88
    v_lshlrev_b32 v86, 16, v89
    v_mul_f32 v84, v84, v84
    v_fmac_f32 v84, v85, v85
    v_fmac_f32 v84, v86, v86
    v_cvt_pk_bf16_f32 v84, v84, v7
    v_lshl_or_b32 v32, v20, 16, v84
    v_alignbit_b32 v33, v21, v20, 16
    v_alignbit_b32 v34, v88, v21, 16
    v_alignbit_b32 v35, v89, v88, 16
    v_and_b32 v81, 7, v9
    v_lshl_or_b32 v57, v81, 14, v15
    v_lshrrev_b32 v81, 3, v9
    v_lshl_or_b32 v57, v81, 17, v57
    v_and_b32 v82, 1, v9
    v_lshlrev_b32 v82, 4, v82
    v_and_b32 v83, 1, v15
    v_lshlrev_b32 v83, 4, v83
    v_alignbit_b32 v100, v101, v100, v82
    v_lshrrev_b32 v101, v82, v101
    v_alignbit_b32 v102, v103, v102, v83
    v_lshrrev_b32 v103, v83, v103
    v_lshlrev_b32 v84, 16, v100
    v_lshlrev_b32 v85, 16, v102
    v_sub_f32 v84, v84, v85
    v_and_b32 v85, s55, v100
    v_and_b32 v86, s55, v102
    v_sub_f32 v85, v85, v86
    v_lshlrev_b32 v86, 16, v101
    v_lshlrev_b32 v87, 16, v103
    v_sub_f32 v86, v86, v87
    v_cvt_pk_bf16_f32 v88, v84, v85
    v_cvt_pk_bf16_f32 v89, v86, v7
    v_lshlrev_b32 v84, 16, v88
    v_and_b32 v85, s55, v88
    v_lshlrev_b32 v86, 16, v89
    v_mul_f32 v84, v84, v84
    v_fmac_f32 v84, v85, v85
    v_fmac_f32 v84, v86, v86
    v_cvt_pk_bf16_f32 v84, v84, v7
    v_lshl_or_b32 v36, v22, 16, v84
    v_alignbit_b32 v37, v23, v22, 16
    v_alignbit_b32 v38, v88, v23, 16
    v_alignbit_b32 v39, v89, v88, 16
    v_and_b32 v81, 7, v10
    v_lshl_or_b32 v58, v81, 14, v16
    v_lshrrev_b32 v81, 3, v10
    v_lshl_or_b32 v58, v81, 17, v58
    v_and_b32 v82, 1, v10
    v_lshlrev_b32 v82, 4, v82
    v_and_b32 v83, 1, v16
    v_lshlrev_b32 v83, 4, v83
    v_alignbit_b32 v104, v105, v104, v82
    v_lshrrev_b32 v105, v82, v105
    v_alignbit_b32 v106, v107, v106, v83
    v_lshrrev_b32 v107, v83, v107
    v_lshlrev_b32 v84, 16, v104
    v_lshlrev_b32 v85, 16, v106
    v_sub_f32 v84, v84, v85
    v_and_b32 v85, s55, v104
    v_and_b32 v86, s55, v106
    v_sub_f32 v85, v85, v86
    v_lshlrev_b32 v86, 16, v105
    v_lshlrev_b32 v87, 16, v107
    v_sub_f32 v86, v86, v87
    v_cvt_pk_bf16_f32 v88, v84, v85
    v_cvt_pk_bf16_f32 v89, v86, v7
    v_lshlrev_b32 v84, 16, v88
    v_and_b32 v85, s55, v88
    v_lshlrev_b32 v86, 16, v89
    v_mul_f32 v84, v84, v84
    v_fmac_f32 v84, v85, v85
    v_fmac_f32 v84, v86, v86
    v_cvt_pk_bf16_f32 v84, v84, v7
    v_lshl_or_b32 v40, v24, 16, v84
    v_alignbit_b32 v41, v25, v24, 16
    v_alignbit_b32 v42, v88, v25, 16
    v_alignbit_b32 v43, v89, v88, 16
    v_and_b32 v81, 7, v11
    v_lshl_or_b32 v59, v81, 14, v17
    v_lshrrev_b32 v81, 3, v11
    v_lshl_or_b32 v59, v81, 17, v59
    v_and_b32 v82, 1, v11
    v_lshlrev_b32 v82, 4, v82
    v_and_b32 v83, 1, v17
    v_lshlrev_b32 v83, 4, v83
    v_alignbit_b32 v108, v109, v108, v82
    v_lshrrev_b32 v109, v82, v109
    v_alignbit_b32 v110, v111, v110, v83
    v_lshrrev_b32 v111, v83, v111
    v_lshlrev_b32 v84, 16, v108
    v_lshlrev_b32 v85, 16, v110
    v_sub_f32 v84, v84, v85
    v_and_b32 v85, s55, v108
    v_and_b32 v86, s55, v110
    v_sub_f32 v85, v85, v86
    v_lshlrev_b32 v86, 16, v109
    v_lshlrev_b32 v87, 16, v111
    v_sub_f32 v86, v86, v87
    v_cvt_pk_bf16_f32 v88, v84, v85
    v_cvt_pk_bf16_f32 v89, v86, v7
    v_lshlrev_b32 v84, 16, v88
    v_and_b32 v85, s55, v88
    v_lshlrev_b32 v86, 16, v89
    v_mul_f32 v84, v84, v84
    v_fmac_f32 v84, v85, v85
    v_fmac_f32 v84, v86, v86
    v_cvt_pk_bf16_f32 v84, v84, v7
    v_lshl_or_b32 v44, v26, 16, v84
    v_alignbit_b32 v45, v27, v26, 16
    v_alignbit_b32 v46, v88, v27, 16
    v_alignbit_b32 v47, v89, v88, 16
    v_and_b32 v81, 7, v12
    v_lshl_or_b32 v60, v81, 14, v18
    v_lshrrev_b32 v81, 3, v12
    v_lshl_or_b32 v60, v81, 17, v60
    v_and_b32 v82, 1, v12
    v_lshlrev_b32 v82, 4, v82
    v_and_b32 v83, 1, v18
    v_lshlrev_b32 v83, 4, v83
    v_alignbit_b32 v112, v113, v112, v82
    v_lshrrev_b32 v113, v82, v113
    v_alignbit_b32 v114, v115, v114, v83
    v_lshrrev_b32 v115, v83, v115
    v_lshlrev_b32 v84, 16, v112
    v_lshlrev_b32 v85, 16, v114
    v_sub_f32 v84, v84, v85
    v_and_b32 v85, s55, v112
    v_and_b32 v86, s55, v114
    v_sub_f32 v85, v85, v86
    v_lshlrev_b32 v86, 16, v113
    v_lshlrev_b32 v87, 16, v115
    v_sub_f32 v86, v86, v87
    v_cvt_pk_bf16_f32 v88, v84, v85
    v_cvt_pk_bf16_f32 v89, v86, v7
    v_lshlrev_b32 v84, 16, v88
    v_and_b32 v85, s55, v88
    v_lshlrev_b32 v86, 16, v89
    v_mul_f32 v84, v84, v84
    v_fmac_f32 v84, v85, v85
    v_fmac_f32 v84, v86, v86
    v_cvt_pk_bf16_f32 v84, v84, v7
    v_lshl_or_b32 v48, v28, 16, v84
    v_alignbit_b32 v49, v29, v28, 16
    v_alignbit_b32 v50, v88, v29, 16
    v_alignbit_b32 v51, v89, v88, 16
    v_and_b32 v81, 7, v13
    v_lshl_or_b32 v61, v81, 14, v19
    v_lshrrev_b32 v81, 3, v13
    v_lshl_or_b32 v61, v81, 17, v61
    v_and_b32 v82, 1, v13
    v_lshlrev_b32 v82, 4, v82
    v_and_b32 v83, 1, v19
    v_lshlrev_b32 v83, 4, v83
    v_alignbit_b32 v116, v117, v116, v82
    v_lshrrev_b32 v117, v82, v117
    v_alignbit_b32 v118, v119, v118, v83
    v_lshrrev_b32 v119, v83, v119
    v_lshlrev_b32 v84, 16, v116
    v_lshlrev_b32 v85, 16, v118
    v_sub_f32 v84, v84, v85
    v_and_b32 v85, s55, v116
    v_and_b32 v86, s55, v118
    v_sub_f32 v85, v85, v86
    v_lshlrev_b32 v86, 16, v117
    v_lshlrev_b32 v87, 16, v119
    v_sub_f32 v86, v86, v87
    v_cvt_pk_bf16_f32 v88, v84, v85
    v_cvt_pk_bf16_f32 v89, v86, v7
    v_lshlrev_b32 v84, 16, v88
    v_and_b32 v85, s55, v88
    v_lshlrev_b32 v86, 16, v89
    v_mul_f32 v84, v84, v84
    v_fmac_f32 v84, v85, v85
    v_fmac_f32 v84, v86, v86
    v_cvt_pk_bf16_f32 v84, v84, v7
    v_lshl_or_b32 v52, v30, 16, v84
    v_alignbit_b32 v53, v31, v30, 16
    v_alignbit_b32 v54, v88, v31, 16
    v_alignbit_b32 v55, v89, v88, 16
    s_waitcnt lgkmcnt(0)
    s_barrier
    s_cmp_ge_u32 s3, 4
    s_cbranch_scc1 L1_sort_t
    v_mul_u32_u24 v7, 20, v0
    v_add_u32 v7, 65536, v7
    ds_read_b32 v84, v7 offset:0
    ds_read_b32 v85, v7 offset:4
    ds_read_b32 v86, v7 offset:8
    ds_read_b32 v87, v7 offset:12
    ds_read_b32 v88, v7 offset:16
    ds_read_b32 v89, v7 offset:20
L1_sort_t:
    ds_read_b32 v76, v62
    ds_read_b32 v77, v63
    ds_read_b32 v78, v64
    ds_read_b32 v79, v65
    ds_read_b32 v80, v66
    s_mov_b64 exec, s[62:63]
    s_cbranch_execz L1_sort_b
    ds_read_b32 v81, v67
L1_sort_b:
    s_mov_b64 exec, -1
    s_waitcnt lgkmcnt(0)
    s_cmp_ge_u32 s3, 4
    s_cbranch_scc1 L1_sort_t2
    v_lshl_or_b32 v92, v85, 16, v84
    v_lshl_or_b32 v93, v87, 16, v86
    v_lshl_or_b32 v94, v89, 16, v88
    v_mov_b32 v95, 0
    s_mul_i32 s52, s58, 4096
    s_add_u32 s52, s52, 19922944
    v_lshlrev_b32 v7, 4, v0
    buffer_store_dwordx4 v[92:95], v7, s[44:47], s52 offen sc1
L1_sort_t2:
    v_add_u32 v76, v76, v68
    v_lshlrev_b32 v82, 4, v76
    v_add_u32 v82, 71680, v82
    ds_write_b128 v82, v[32:35]
    v_lshlrev_b32 v83, 2, v76
    v_add_u32 v83, 114688, v83
    ds_write_b32 v83, v56
    v_add_u32 v77, v77, v69
    v_lshlrev_b32 v82, 4, v77
    v_add_u32 v82, 71680, v82
    ds_write_b128 v82, v[36:39]
    v_lshlrev_b32 v83, 2, v77
    v_add_u32 v83, 114688, v83
    ds_write_b32 v83, v57
    v_add_u32 v78, v78, v70
    v_lshlrev_b32 v82, 4, v78
    v_add_u32 v82, 71680, v82
    ds_write_b128 v82, v[40:43]
    v_lshlrev_b32 v83, 2, v78
    v_add_u32 v83, 114688, v83
    ds_write_b32 v83, v58
    v_add_u32 v79, v79, v71
    v_lshlrev_b32 v82, 4, v79
    v_add_u32 v82, 71680, v82
    ds_write_b128 v82, v[44:47]
    v_lshlrev_b32 v83, 2, v79
    v_add_u32 v83, 114688, v83
    ds_write_b32 v83, v59
    v_add_u32 v80, v80, v72
    v_lshlrev_b32 v82, 4, v80
    v_add_u32 v82, 71680, v82
    ds_write_b128 v82, v[48:51]
    v_lshlrev_b32 v83, 2, v80
    v_add_u32 v83, 114688, v83
    ds_write_b32 v83, v60
    s_mov_b64 exec, s[62:63]
    s_cbranch_execz L1_sort_c
    v_add_u32 v81, v81, v73
    v_lshlrev_b32 v82, 4, v81
    v_add_u32 v82, 71680, v82
    ds_write_b128 v82, v[52:55]
    v_lshlrev_b32 v83, 2, v81
    v_add_u32 v83, 114688, v83
    ds_write_b32 v83, v61
L1_sort_c:
    s_mov_b64 exec, -1
    s_waitcnt lgkmcnt(0)
    s_barrier
    v_lshlrev_b32 v4, 4, v0
    v_add_u32 v5, 71680, v4
    ds_read_b128 v[32:35], v5 offset:0
    ds_read_b128 v[36:39], v5 offset:8192
    ds_read_b128 v[40:43], v5 offset:16384
    ds_read_b128 v[44:47], v5 offset:24576
    ds_read_b128 v[48:51], v5 offset:32768
    ds_read_b128 v[52:55], v5 offset:40960
    v_add_u32 v7, 114688, v4
    ds_read_b128 v[76:79], v7
    ds_read_b128 v[80:83], v7 offset:8192
    s_mul_i32 s52, s58, 43008
    s_add_u32 s52, s52, 15728640
    s_mul_i32 s53, s58, 10752
    s_add_u32 s53, s53, 18874368
    s_waitcnt lgkmcnt(0)
    buffer_store_dwordx4 v[32:35], v4, s[44:47], s52 offen sc1
    s_add_u32 s52, s52, 8192
    buffer_store_dwordx4 v[36:39], v4, s[44:47], s52 offen sc1
    s_add_u32 s52, s52, 8192
    buffer_store_dwordx4 v[40:43], v4, s[44:47], s52 offen sc1
    s_add_u32 s52, s52, 8192
    buffer_store_dwordx4 v[44:47], v4, s[44:47], s52 offen sc1
    s_add_u32 s52, s52, 8192
    buffer_store_dwordx4 v[48:51], v4, s[44:47], s52 offen sc1
    s_add_u32 s52, s52, 8192
    buffer_store_dwordx4 v[76:79], v4, s[44:47], s53 offen sc1
    s_cmp_ge_u32 s3, 2
    s_cbranch_scc1 L1_sort_r1
    buffer_store_dwordx4 v[52:55], v4, s[44:47], s52 offen sc1
L1_sort_r1:
    s_cmp_ge_u32 s3, 3
    s_cbranch_scc1 L1_sort_r2
    s_movk_i32 s54, 160
    v_cmp_gt_u32 vcc, s54, v0
    s_and_b64 exec, exec, vcc
    s_add_u32 s53, s53, 8192
    buffer_store_dwordx4 v[80:83], v4, s[44:47], s53 offen sc1
    s_mov_b64 exec, -1
L1_sort_r2:
    s_waitcnt lgkmcnt(0)
    s_barrier
    v_mov_b32 v36, 0
    v_mov_b32 v37, 0
    v_mov_b32 v38, 0
    v_mov_b32 v39, 0
    v_lshlrev_b32 v40, 4, v0
    v_add_u32 v41, 0x10000, v40
    ds_write_b128 v40, v[36:39] offset:0
    ds_write_b128 v40, v[36:39] offset:8192
    ds_write_b128 v40, v[36:39] offset:16384
    ds_write_b128 v40, v[36:39] offset:24576
    ds_write_b128 v40, v[36:39] offset:32768
    ds_write_b128 v40, v[36:39] offset:40960
    ds_write_b128 v40, v[36:39] offset:49152
    ds_write_b128 v40, v[36:39] offset:57344
    ds_write_b128 v41, v[36:39]
    s_cmp_eq_u32 s3, 0
    s_cbranch_scc0 1f
    v_add_u32 v41, 160512, v40
    s_mov_b32 exec_lo, -1
    s_mov_b32 exec_hi, 0xff
    ds_write_b128 v41, v[36:39]
    s_mov_b64 exec, -1
1:
    s_mov_b32 s84, 0x100
    s_waitcnt vmcnt(0) lgkmcnt(0)
    s_barrier
    s_branch L_phase2
L1_pack:
    s_cmp_lg_u32 s3, 7
    s_cbranch_scc1 L1_pack_go
    s_add_u32 s44, s20, 21135360
    s_addc_u32 s45, s21, 0
    s_mov_b32 s46, 2048
    s_mov_b32 s47, 0x20000
    v_lshlrev_b32 v2, 7, v1
    v_mov_b32 v4, 0
    v_mov_b32 v5, 0
    s_mov_b32 exec_lo, 0xffff
    s_mov_b32 exec_hi, 0
    buffer_store_dwordx2 v[4:5], v2, s[44:47], 0 offen sc1
    s_waitcnt vmcnt(0)
    s_mov_b64 exec, -1
    s_mov_b32 s48, s24
    s_mov_b32 s49, s25
    s_mov_b32 s50, 256
    s_mov_b32 s51, 0x20000
    v_mov_b32 v2, 0
    v_mov_b32 v3, 0x1
    s_mov_b32 exec_lo, 1
    s_mov_b32 exec_hi, 0
    buffer_atomic_add v3, v2, s[48:51], 0 offen sc0 sc1
    s_mov_b64 exec, -1
    s_waitcnt vmcnt(0)
    v_readfirstlane_b32 s52, v3
    s_add_u32 s85, s52, 0x1
    s_and_b32 s53, s85, 0xffff
    s_cmp_eq_u32 s53, 0x3c01
    s_cbranch_scc0 L_arr1_i
    s_and_b32 s53, s52, 0xffff
    s_cmp_eq_u32 s53, 0x3c01
    s_cbranch_scc1 L_arr1_i
    s_add_u32 s44, s20, 21135360
    s_addc_u32 s45, s21, 0
    s_mov_b32 s46, 2048
    s_mov_b32 s47, 0x20000
    v_lshlrev_b32 v2, 7, v1
    v_mov_b32 v3, 1
    s_mov_b32 exec_lo, 0xffff
    s_mov_b32 exec_hi, 0
    buffer_store_dword v3, v2, s[44:47], 0 offen offset:0 sc1
    s_mov_b64 exec, -1
L_arr1_i:
    s_and_b32 s53, s85, 0xffff00ff
    s_cmp_eq_u32 s53, 0xbe0001
    s_cbranch_scc0 L_arr2_i
    s_and_b32 s53, s52, 0xffff00ff
    s_cmp_eq_u32 s53, 0xbe0001
    s_cbranch_scc1 L_arr2_i
    s_add_u32 s44, s20, 21135360
    s_addc_u32 s45, s21, 0
    s_mov_b32 s46, 2048
    s_mov_b32 s47, 0x20000
    v_lshlrev_b32 v2, 7, v1
    v_mov_b32 v3, 1
    s_mov_b32 exec_lo, 0xffff
    s_mov_b32 exec_hi, 0
    buffer_store_dword v3, v2, s[44:47], 0 offen offset:4 sc1
    s_mov_b64 exec, -1
L_arr2_i:
L1_pack_go:
    s_add_u32 s28, s18, 131072
    s_addc_u32 s29, s19, 0
    s_mov_b32 s30, 131072
    s_mov_b32 s31, 0x20000
    s_add_u32 s36, s20, 20971520
    s_addc_u32 s37, s21, 0
    s_mov_b32 s38, 131072
    s_mov_b32 s39, 0x20000
    v_lshrrev_b32 v2, 2, v1
    v_lshlrev_b32 v2, 9, v2
    v_and_b32 v3, 3, v1
    v_lshl_add_u32 v2, v3, 4, v2
    s_lshl_b32 s52, s3, 6
    v_add_u32 v2, s52, v2
    s_lshl_b32 s53, s3, 14
    s_add_u32 m0, s53, 0
    s_mov_b32 s54, 0
    buffer_load_dwordx4 v2, s[28:31], s54 offen lds
    s_add_u32 m0, s53, 1024
    s_mov_b32 s54, 8192
    buffer_load_dwordx4 v2, s[28:31], s54 offen lds
    s_add_u32 m0, s53, 2048
    s_mov_b32 s54, 16384
    buffer_load_dwordx4 v2, s[28:31], s54 offen lds
    s_add_u32 m0, s53, 3072
    s_mov_b32 s54, 24576
    buffer_load_dwordx4 v2, s[28:31], s54 offen lds
    s_add_u32 m0, s53, 4096
    s_mov_b32 s54, 32768
    buffer_load_dwordx4 v2, s[28:31], s54 offen lds
    s_add_u32 m0, s53, 5120
    s_mov_b32 s54, 40960
    buffer_load_dwordx4 v2, s[28:31], s54 offen lds
    s_add_u32 m0, s53, 6144
    s_mov_b32 s54, 49152
    buffer_load_dwordx4 v2, s[28:31], s54 offen lds
    s_add_u32 m0, s53, 7168
    s_mov_b32 s54, 57344
    buffer_load_dwordx4 v2, s[28:31], s54 offen lds
    s_add_u32 m0, s53, 8192
    s_mov_b32 s54, 65536
    buffer_load_dwordx4 v2, s[28:31], s54 offen lds
    s_add_u32 m0, s53, 9216
    s_mov_b32 s54, 73728
    buffer_load_dwordx4 v2, s[28:31], s54 offen lds
    s_add_u32 m0, s53, 10240
    s_mov_b32 s54, 81920
    buffer_load_dwordx4 v2, s[28:31], s54 offen lds
    s_add_u32 m0, s53, 11264
    s_mov_b32 s54, 90112
    buffer_load_dwordx4 v2, s[28:31], s54 offen lds
    s_add_u32 m0, s53, 12288
    s_mov_b32 s54, 98304
    buffer_load_dwordx4 v2, s[28:31], s54 offen lds
    s_add_u32 m0, s53, 13312
    s_mov_b32 s54, 106496
    buffer_load_dwordx4 v2, s[28:31], s54 offen lds
    s_add_u32 m0, s53, 14336
    s_mov_b32 s54, 114688
    buffer_load_dwordx4 v2, s[28:31], s54 offen lds
    s_add_u32 m0, s53, 15360
    s_mov_b32 s54, 122880
    buffer_load_dwordx4 v2, s[28:31], s54 offen lds
    s_mov_b32 s32, s14
    s_mov_b32 s33, s15
    s_mov_b32 s34, 264704
    s_mov_b32 s35, 0x20000
    s_mov_b32 s40, s16
    s_mov_b32 s41, s17
    s_mov_b32 s42, 512
    s_mov_b32 s43, 0x20000
    s_mov_b32 s44, s20
    s_mov_b32 s45, s21
    s_mov_b32 s46, 21168128
    s_mov_b32 s47, 0x20000
    v_lshlrev_b32 v9, 1, v0
    s_mov_b32 s52, 0x40000
    buffer_load_ushort v24, v9, s[32:35], s52 offen offset:0
    buffer_load_ushort v25, v9, s[32:35], s52 offen offset:512
    buffer_load_ushort v26, v9, s[32:35], s52 offen offset:1024
    buffer_load_ushort v27, v9, s[32:35], s52 offen offset:1536
    buffer_load_ushort v28, v9, s[32:35], s52 offen offset:2048
    v_lshrrev_b32 v10, 2, v1
    v_lshlrev_b32 v10, 5, v10
    v_bfe_u32 v11, v1, 1, 1
    v_lshl_add_u32 v10, v11, 4, v10
    v_and_b32 v11, 1, v1
    v_lshl_add_u32 v10, v11, 2, v10
    v_lshlrev_b32 v10, 1, v10
    buffer_load_dwordx2 v[32:33], v10, s[40:43], 0 offen
    buffer_load_dwordx2 v[34:35], v10, s[40:43], 0 offen offset:16
    v_lshrrev_b32 v5, 4, v1
    v_and_b32 v6, 1, v5
    v_lshlrev_b32 v6, 4, v6
    v_lshrrev_b32 v7, 1, v5
    v_lshl_add_u32 v6, v7, 2, v6
    v_bfe_u32 v7, v1, 2, 2
    v_add_u32 v6, v6, v7
    v_lshlrev_b32 v6, 6, v6
    v_and_b32 v7, 3, v1
    v_lshl_add_u32 v6, v7, 4, v6
    s_lshl_b32 s53, s3, 14
    v_add_u32 v5, s53, v6
    v_lshlrev_b32 v8, 4, v1
    v_and_b32 v100, 31, v1
    v_lshrrev_b32 v101, 5, v1
    s_lshl_b32 s80, s3, 13
    s_add_u32 s80, s80, 73216
    v_bfe_u32 v102, v100, 2, 2
    v_xor_b32 v103, v101, v102
    v_lshlrev_b32 v104, 6, v100
    v_add_u32 v105, s80, v104
    v_lshl_add_u32 v214, v103, 4, v105
    v_xor_b32 v103, 2, v103
    v_lshl_add_u32 v215, v103, 4, v105
    v_lshlrev_b32 v103, 4, v100
    v_add_u32 v103, 2048, v103
    v_lshl_add_u32 v104, v102, 4, v104
    v_cmp_eq_u32 vcc, 1, v101
    v_bfe_u32 v102, v1, 2, 2
    v_lshl_add_u32 v102, v101, 2, v102
    v_cndmask_b32 v225, v103, v104, vcc
    v_lshlrev_b32 v102, 6, v102
    v_and_b32 v103, 1, v1
    v_lshl_add_u32 v102, v103, 3, v102
    v_bfe_u32 v103, v1, 4, 1
    v_lshlrev_b32 v103, 1, v103
    v_bfe_u32 v104, v1, 1, 1
    v_or_b32 v103, v103, v104
    v_xor_b32 v103, v103, v101
    v_lshl_add_u32 v226, v103, 4, v102
    v_xor_b32 v103, 2, v103
    v_lshl_add_u32 v104, v103, 4, v102
    v_add_u32 v227, 512, v104
    v_and_b32 v102, 3, v1
    v_bfe_u32 v103, v1, 4, 2
    v_xor_b32 v102, v102, v103
    v_lshlrev_b32 v102, 4, v102
    s_lshl_b32 s52, s3, 6
    s_sub_u32 s53, s52, 512
    v_add_u32 v220, s53, v102
    v_and_b32 v102, 7, v1
    v_mul_u32_u24 v102, 544, v102
    v_lshl_add_u32 v102, v101, 5, v102
    s_add_u32 s52, s52, 138752
    v_add_u32 v221, s52, v102
    v_lshlrev_b32 v102, 2, v100
    v_add_u32 v222, 160512, v102
    v_lshrrev_b32 v102, 2, v1
    v_lshlrev_b32 v102, 2, v102
    v_add_u32 v240, 69120, v102
    v_and_b32 v100, 31, v1
    v_lshrrev_b32 v101, 5, v1
    v_mov_b32 v208, 1.0
    v_mov_b32 v209, 1.0
    v_mov_b32 v236, 0
    v_mov_b32 v237, 0
    v_mov_b32 v238, 0
    v_mov_b32 v239, 0
    s_mov_b32 s86, 0xff
    s_mov_b32 s87, 0xff
    v_lshlrev_b32 v102, 3, v101
    v_sub_u32 v102, v100, v102
    v_mov_b32 v104, 0x3f80
    v_mov_b32 v105, 0x3f800000
    v_and_b32 v103, 1, v102
    v_cmp_eq_u32 vcc, 1, v103
    v_lshrrev_b32 v106, 1, v102
    v_add_u32 v107, -8, v106
    v_cndmask_b32 v103, v104, v105, vcc
    v_cmp_eq_u32 s[64:65], 0, v106
    v_cmp_eq_u32 s[66:67], 1, v106
    s_nop 0
    v_cndmask_b32 v200, 0, v103, s[64:65]
    v_cndmask_b32 v201, 0, v103, s[66:67]
    v_cmp_eq_u32 s[64:65], 2, v106
    v_cmp_eq_u32 s[66:67], 3, v106
    s_nop 0
    v_cndmask_b32 v202, 0, v103, s[64:65]
    v_cndmask_b32 v203, 0, v103, s[66:67]
    v_cmp_eq_u32 s[64:65], 0, v107
    v_cmp_eq_u32 s[66:67], 1, v107
    s_nop 0
    v_cndmask_b32 v204, 0, v103, s[64:65]
    v_cndmask_b32 v205, 0, v103, s[66:67]
    v_cmp_eq_u32 s[64:65], 2, v107
    v_cmp_eq_u32 s[66:67], 3, v107
    s_nop 0
    v_cndmask_b32 v206, 0, v103, s[64:65]
    v_cndmask_b32 v207, 0, v103, s[66:67]
    s_lshl_b32 s53, s3, 14
    s_waitcnt vmcnt(0) lgkmcnt(0)
    ds_read_b64_tr_b16 v[64:65], v5 offset:0
    ds_read_b64_tr_b16 v[66:67], v5 offset:512
    ds_read_b64_tr_b16 v[68:69], v5 offset:2048
    ds_read_b64_tr_b16 v[70:71], v5 offset:2560
    ds_read_b64_tr_b16 v[72:73], v5 offset:4096
    ds_read_b64_tr_b16 v[74:75], v5 offset:4608
    ds_read_b64_tr_b16 v[76:77], v5 offset:6144
    ds_read_b64_tr_b16 v[78:79], v5 offset:6656
    s_waitcnt lgkmcnt(0)
    ds_read_b64_tr_b16 v[80:81], v5 offset:8192
    ds_read_b64_tr_b16 v[82:83], v5 offset:8704
    ds_read_b64_tr_b16 v[84:85], v5 offset:10240
    ds_read_b64_tr_b16 v[86:87], v5 offset:10752
    ds_read_b64_tr_b16 v[88:89], v5 offset:12288
    ds_read_b64_tr_b16 v[90:91], v5 offset:12800
    ds_read_b64_tr_b16 v[92:93], v5 offset:14336
    ds_read_b64_tr_b16 v[94:95], v5 offset:14848
    s_waitcnt lgkmcnt(0)
    ds_read_b64_tr_b16 v[96:97], v5 offset:8
    ds_read_b64_tr_b16 v[98:99], v5 offset:520
    ds_read_b64_tr_b16 v[100:101], v5 offset:2056
    ds_read_b64_tr_b16 v[102:103], v5 offset:2568
    ds_read_b64_tr_b16 v[104:105], v5 offset:4104
    ds_read_b64_tr_b16 v[106:107], v5 offset:4616
    ds_read_b64_tr_b16 v[108:109], v5 offset:6152
    ds_read_b64_tr_b16 v[110:111], v5 offset:6664
    s_waitcnt lgkmcnt(0)
    ds_read_b64_tr_b16 v[112:113], v5 offset:8200
    ds_read_b64_tr_b16 v[114:115], v5 offset:8712
    ds_read_b64_tr_b16 v[116:117], v5 offset:10248
    ds_read_b64_tr_b16 v[118:119], v5 offset:10760
    ds_read_b64_tr_b16 v[120:121], v5 offset:12296
    ds_read_b64_tr_b16 v[122:123], v5 offset:12808
    ds_read_b64_tr_b16 v[124:125], v5 offset:14344
    ds_read_b64_tr_b16 v[126:127], v5 offset:14856
    s_waitcnt lgkmcnt(0)
    s_add_u32 s54, s53, 0
    buffer_store_dwordx4 v[64:67], v8, s[36:39], s54 offen sc1
    s_add_u32 s54, s53, 1024
    buffer_store_dwordx4 v[68:71], v8, s[36:39], s54 offen sc1
    s_add_u32 s54, s53, 2048
    buffer_store_dwordx4 v[72:75], v8, s[36:39], s54 offen sc1
    s_add_u32 s54, s53, 3072
    buffer_store_dwordx4 v[76:79], v8, s[36:39], s54 offen sc1
    s_add_u32 s54, s53, 4096
    buffer_store_dwordx4 v[80:83], v8, s[36:39], s54 offen sc1
    s_add_u32 s54, s53, 5120
    buffer_store_dwordx4 v[84:87], v8, s[36:39], s54 offen sc1
    s_add_u32 s54, s53, 6144
    buffer_store_dwordx4 v[88:91], v8, s[36:39], s54 offen sc1
    s_add_u32 s54, s53, 7168
    buffer_store_dwordx4 v[92:95], v8, s[36:39], s54 offen sc1
    s_add_u32 s54, s53, 8192
    buffer_store_dwordx4 v[96:99], v8, s[36:39], s54 offen sc1
    s_add_u32 s54, s53, 9216
    buffer_store_dwordx4 v[100:103], v8, s[36:39], s54 offen sc1
    s_add_u32 s54, s53, 10240
    buffer_store_dwordx4 v[104:107], v8, s[36:39], s54 offen sc1
    s_add_u32 s54, s53, 11264
    buffer_store_dwordx4 v[108:111], v8, s[36:39], s54 offen sc1
    s_add_u32 s54, s53, 12288
    buffer_store_dwordx4 v[112:115], v8, s[36:39], s54 offen sc1
    s_add_u32 s54, s53, 13312
    buffer_store_dwordx4 v[116:119], v8, s[36:39], s54 offen sc1
    s_add_u32 s54, s53, 14336
    buffer_store_dwordx4 v[120:123], v8, s[36:39], s54 offen sc1
    s_add_u32 s54, s53, 15360
    buffer_store_dwordx4 v[124:127], v8, s[36:39], s54 offen sc1
    s_cmp_ge_u32 s3, 4
    s_cbranch_scc1 L1_pack_b
    s_mov_b32 s56, 0xbfb8aa3b
    v_lshlrev_b32 v24, 16, v24
    v_mul_f32 v24, s56, v24
    v_lshlrev_b32 v25, 16, v25
    v_mul_f32 v25, s56, v25
    v_lshlrev_b32 v26, 16, v26
    v_mul_f32 v26, s56, v26
    v_lshlrev_b32 v27, 16, v27
    v_mul_f32 v27, s56, v27
    v_lshlrev_b32 v28, 16, v28
    v_mul_f32 v28, s56, v28
    v_mov_b32 v29, 0
    v_cvt_pk_bf16_f32 v36, v24, v25
    v_cvt_pk_bf16_f32 v37, v26, v27
    v_cvt_pk_bf16_f32 v38, v28, v29
    v_mov_b32 v39, 0
    v_lshlrev_b32 v3, 4, v0
    s_mov_b32 s52, 21102592
    buffer_store_dwordx4 v[36:39], v3, s[44:47], s52 offen sc1
    s_branch L1_pack_e
L1_pack_b:
    s_cmp_gt_u32 s3, 4
    s_cbranch_scc1 L1_pack_e
    v_lshlrev_b32 v3, 4, v1
    s_mov_b32 s52, 21106688
    s_mov_b32 exec_hi, 0
    buffer_store_dwordx4 v[32:35], v3, s[44:47], s52 offen sc1
    s_mov_b64 exec, -1
L1_pack_e:
    s_waitcnt lgkmcnt(0)
    s_barrier
    v_mov_b32 v36, 0
    v_mov_b32 v37, 0
    v_mov_b32 v38, 0
    v_mov_b32 v39, 0
    v_lshlrev_b32 v40, 4, v0
    v_add_u32 v41, 0x10000, v40
    ds_write_b128 v40, v[36:39] offset:0
    ds_write_b128 v40, v[36:39] offset:8192
    ds_write_b128 v40, v[36:39] offset:16384
    ds_write_b128 v40, v[36:39] offset:24576
    ds_write_b128 v40, v[36:39] offset:32768
    ds_write_b128 v40, v[36:39] offset:40960
    ds_write_b128 v40, v[36:39] offset:49152
    ds_write_b128 v40, v[36:39] offset:57344
    ds_write_b128 v41, v[36:39]
    s_cmp_eq_u32 s3, 0
    s_cbranch_scc0 1f
    v_add_u32 v41, 160512, v40
    s_mov_b32 exec_lo, -1
    s_mov_b32 exec_hi, 0xff
    ds_write_b128 v41, v[36:39]
    s_mov_b64 exec, -1
1:
    s_mov_b32 s84, 0x10000
    s_waitcnt vmcnt(0) lgkmcnt(0)
    s_barrier
    s_branch L_phase2
L_phase2_fast:
    v_and_b32 v1, 63, v0
    s_cmp_eq_u32 s3, 0
    s_cbranch_scc0 2f
    s_mov_b32 s48, s24
    s_mov_b32 s49, s25
    s_mov_b32 s50, 256
    s_mov_b32 s51, 0x20000
    v_mov_b32 v2, 0
    v_mov_b32 v3, s84
    s_mov_b32 exec_lo, 1
    s_mov_b32 exec_hi, 0
    buffer_atomic_add v3, v2, s[48:51], 0 offen sc0 sc1
    s_mov_b64 exec, -1
2:
    s_mov_b32 s28, s20
    s_mov_b32 s29, s21
    s_mov_b32 s30, 21168128
    s_mov_b32 s31, 0x20000
    s_mul_i32 s81, s2, 5
    s_add_u32 s44, s20, 19922944
    s_addc_u32 s45, s21, 0
    s_mov_b32 s46, 245760
    s_mov_b32 s47, 0x20000
    v_lshlrev_b32 v2, 12, v1
    s_lshl_b32 s52, s2, 4
    buffer_load_dwordx3 v[60:62], v2, s[44:47], s52 offen sc1
    s_cmp_eq_u32 s3, 0
    s_cbranch_scc0 L2_tab
    s_waitcnt vmcnt(0)
    v_readfirstlane_b32 s52, v3
    s_add_u32 s85, s52, s84
    s_and_b32 s53, s85, 0xffff
    s_cmp_eq_u32 s53, 0x3c01
    s_cbranch_scc0 L_arr1_f
    s_and_b32 s53, s52, 0xffff
    s_cmp_eq_u32 s53, 0x3c01
    s_cbranch_scc1 L_arr1_f
    s_add_u32 s44, s20, 21135360
    s_addc_u32 s45, s21, 0
    s_mov_b32 s46, 2048
    s_mov_b32 s47, 0x20000
    v_lshlrev_b32 v2, 7, v1
    v_mov_b32 v3, 1
    s_mov_b32 exec_lo, 0xffff
    s_mov_b32 exec_hi, 0
    buffer_store_dword v3, v2, s[44:47], 0 offen offset:0 sc1
    s_mov_b64 exec, -1
L_arr1_f:
    s_and_b32 s53, s85, 0xffff00ff
    s_cmp_eq_u32 s53, 0xbe0001
    s_cbranch_scc0 L_arr2_f
    s_and_b32 s53, s52, 0xffff00ff
    s_cmp_eq_u32 s53, 0xbe0001
    s_cbranch_scc1 L_arr2_f
    s_add_u32 s44, s20, 21135360
    s_addc_u32 s45, s21, 0
    s_mov_b32 s46, 2048
    s_mov_b32 s47, 0x20000
    v_lshlrev_b32 v2, 7, v1
    v_mov_b32 v3, 1
    s_mov_b32 exec_lo, 0xffff
    s_mov_b32 exec_hi, 0
    buffer_store_dword v3, v2, s[44:47], 0 offen offset:4 sc1
    s_mov_b64 exec, -1
L_arr2_f:
    s_branch L2_tab
L_phase2:
    v_and_b32 v1, 63, v0
    s_cmp_eq_u32 s3, 0
    s_cbranch_scc0 2f
    s_mov_b32 s48, s24
    s_mov_b32 s49, s25
    s_mov_b32 s50, 256
    s_mov_b32 s51, 0x20000
    v_mov_b32 v2, 0
    v_mov_b32 v3, s84
    s_mov_b32 exec_lo, 1
    s_mov_b32 exec_hi, 0
    buffer_atomic_add v3, v2, s[48:51], 0 offen sc0 sc1
    s_mov_b64 exec, -1
2:
    s_mov_b32 s28, s20
    s_mov_b32 s29, s21
    s_mov_b32 s30, 21168128
    s_mov_b32 s31, 0x20000
    s_mul_i32 s81, s2, 5
    s_cmp_eq_u32 s3, 0
    s_cbranch_scc0 L2_w1
    s_waitcnt vmcnt(0)
    v_readfirstlane_b32 s52, v3
    s_add_u32 s85, s52, s84
    s_and_b32 s53, s85, 0xffff
    s_cmp_eq_u32 s53, 0x3c01
    s_cbranch_scc0 L_arr1_a
    s_and_b32 s53, s52, 0xffff
    s_cmp_eq_u32 s53, 0x3c01
    s_cbranch_scc1 L_arr1_a
    s_add_u32 s44, s20, 21135360
    s_addc_u32 s45, s21, 0
    s_mov_b32 s46, 2048
    s_mov_b32 s47, 0x20000
    v_lshlrev_b32 v2, 7, v1
    v_mov_b32 v3, 1
    s_mov_b32 exec_lo, 0xffff
    s_mov_b32 exec_hi, 0
    buffer_store_dword v3, v2, s[44:47], 0 offen offset:0 sc1
    s_mov_b64 exec, -1
L_arr1_a:
    s_and_b32 s53, s85, 0xffff00ff
    s_cmp_eq_u32 s53, 0xbe0001
    s_cbranch_scc0 L_arr2_a
    s_and_b32 s53, s52, 0xffff00ff
    s_cmp_eq_u32 s53, 0xbe0001
    s_cbranch_scc1 L_arr2_a
    s_add_u32 s44, s20, 21135360
    s_addc_u32 s45, s21, 0
    s_mov_b32 s46, 2048
    s_mov_b32 s47, 0x20000
    v_lshlrev_b32 v2, 7, v1
    v_mov_b32 v3, 1
    s_mov_b32 exec_lo, 0xffff
    s_mov_b32 exec_hi, 0
    buffer_store_dword v3, v2, s[44:47], 0 offen offset:4 sc1
    s_mov_b64 exec, -1
L_arr2_a:
    s_and_b32 s52, s85, 1
    s_cmp_eq_u32 s52, 1
    s_cbranch_scc1 L2_inited
    s_mov_b32 s48, s24
    s_mov_b32 s49, s25
    s_mov_b32 s50, 256
    s_mov_b32 s51, 0x20000
    v_mov_b32 v8, 0
    s_mov_b32 s53, 0x8000
    s_mov_b32 exec_lo, 1
    s_mov_b32 exec_hi, 0
L2_poll0:
    buffer_load_dword v10, v8, s[48:51], 0 offen sc1
    s_waitcnt vmcnt(0)
    v_readfirstlane_b32 s52, v10
    s_and_b32 s52, s52, 0x1
    s_cmp_eq_u32 s52, 0x1
    s_cbranch_scc1 L2_poll0_ok
    s_sub_u32 s53, s53, 1
    s_cmp_eq_u32 s53, 0
    s_cbranch_scc1 L2_poll0_ok
    s_sleep 16
    s_branch L2_poll0
L2_poll0_ok:
    s_mov_b64 exec, -1
    s_mov_b32 s85, 0
L2_inited:
    s_and_b32 s52, s85, 0xffff
    s_cmp_eq_u32 s52, 0x3c01
    s_cbranch_scc1 L2_w1
    s_add_u32 s44, s20, 21135360
    s_addc_u32 s45, s21, 0
    s_mov_b32 s46, 2048
    s_mov_b32 s47, 0x20000
    s_and_b32 s54, s2, 15
    s_lshl_b32 s54, s54, 7
    s_add_u32 s54, s54, 0
    v_mov_b32 v8, s54
    s_mov_b32 s53, 0x8000
    s_mov_b32 exec_lo, 1
    s_mov_b32 exec_hi, 0
L2_poll1:
    buffer_load_dword v10, v8, s[44:47], 0 offen sc1
    s_waitcnt vmcnt(0)
    v_readfirstlane_b32 s52, v10
    s_and_b32 s52, s52, 0x1
    s_cmp_eq_u32 s52, 0x1
    s_cbranch_scc1 L2_poll1_ok
    s_sub_u32 s53, s53, 1
    s_cmp_eq_u32 s53, 0
    s_cbranch_scc1 L2_poll1_ok
    s_sleep 2
    s_branch L2_poll1
L2_poll1_ok:
    s_mov_b64 exec, -1
L2_w1:
    s_barrier
    s_add_u32 s44, s20, 19922944
    s_addc_u32 s45, s21, 0
    s_mov_b32 s46, 245760
    s_mov_b32 s47, 0x20000
    v_lshlrev_b32 v2, 12, v1
    s_lshl_b32 s52, s2, 4
    buffer_load_dwordx3 v[60:62], v2, s[44:47], s52 offen sc1
L2_tab:
    s_mov_b32 s82, 0
    s_mov_b32 s66, 0
    s_mov_b32 s83, 1
    v_mfma_f32_32x32x16_bf16 v[64:79], v[236:239], v[236:239], 0
    s_waitcnt vmcnt(0)
    v_and_b32 v46, 0xffff, v60
    v_lshrrev_b32 v47, 16, v62
    v_sub_u32 v47, v47, v46
    v_lshrrev_b32 v44, 4, v1
    s_lshl_b32 s52, s3, 2
    v_add_u32 v44, s52, v44
    s_mov_b32 s52, 43008
    v_mul_lo_u32 v42, s52, v44
    s_movk_i32 s52, 10752
    v_mul_lo_u32 v43, s52, v44
    v_lshlrev_b32 v40, 2, v44
    v_and_b32 v41, 15, v1
    v_add_u32 v45, 128, v40
    ds_bpermute_b32 v223, v40, v46
    ds_bpermute_b32 v224, v40, v47
    ds_bpermute_b32 v12, v45, v46
    ds_bpermute_b32 v13, v45, v47
    s_waitcnt lgkmcnt(0)
    v_add_u32 v36, s82, v41
    v_cmp_lt_u32 s[56:57], v36, v224
    v_add_u32 v36, v36, v223
    v_lshl_add_u32 v37, v36, 4, v42
    v_lshl_add_u32 v38, v36, 2, v43
    s_mov_b32 s26, 15728640
    s_mov_b32 s27, 18874368
    s_mov_b64 exec, s[56:57]
    s_cbranch_execz L2_ld0_0
    buffer_load_dwordx4 v[16:19], v37, s[28:31], s26 offen sc1
    buffer_load_dword v32, v38, s[28:31], s27 offen sc1
L2_ld0_0:
    s_mov_b64 exec, -1
    v_add_u32 v36, s82, v41
    v_cmp_lt_u32 s[58:59], v36, v13
    v_add_u32 v36, v36, v12
    v_lshl_add_u32 v37, v36, 4, v42
    v_lshl_add_u32 v38, v36, 2, v43
    s_mov_b32 s26, 17104896
    s_mov_b32 s27, 19218432
    s_mov_b64 exec, s[58:59]
    s_cbranch_execz L2_ld0_1
    buffer_load_dwordx4 v[20:23], v37, s[28:31], s26 offen sc1
    buffer_load_dword v33, v38, s[28:31], s27 offen sc1
L2_ld0_1:
    s_mov_b64 exec, -1
    v_add_u32 v36, s82, v41
    v_add_u32 v36, 16, v36
    v_cmp_lt_u32 s[60:61], v36, v224
    v_add_u32 v36, v36, v223
    v_lshl_add_u32 v37, v36, 4, v42
    v_lshl_add_u32 v38, v36, 2, v43
    s_mov_b32 s26, 15728640
    s_mov_b32 s27, 18874368
    s_mov_b64 exec, s[60:61]
    s_cbranch_execz L2_ld0_2
    buffer_load_dwordx4 v[24:27], v37, s[28:31], s26 offen sc1
    buffer_load_dword v34, v38, s[28:31], s27 offen sc1
L2_ld0_2:
    s_mov_b64 exec, -1
    v_add_u32 v36, s82, v41
    v_add_u32 v36, 16, v36
    v_cmp_lt_u32 s[62:63], v36, v13
    v_add_u32 v36, v36, v12
    v_lshl_add_u32 v37, v36, 4, v42
    v_lshl_add_u32 v38, v36, 2, v43
    s_mov_b32 s26, 17104896
    s_mov_b32 s27, 19218432
    s_mov_b64 exec, s[62:63]
    s_cbranch_execz L2_ld0_3
    buffer_load_dwordx4 v[28:31], v37, s[28:31], s26 offen sc1
    buffer_load_dword v35, v38, s[28:31], s27 offen sc1
L2_ld0_3:
    s_mov_b64 exec, -1
    s_cmp_ge_u32 s3, 5
    s_cbranch_scc1 L2_noscan
    s_cmp_lt_u32 s3, 2
    s_cbranch_scc1 L2_sel
    v_mov_b32 v60, v61
    v_mov_b32 v61, v62
    s_cmp_lt_u32 s3, 4
    s_cbranch_scc1 L2_sel
    v_mov_b32 v60, v61
L2_sel:
    s_and_b32 s52, s3, 1
    s_lshl_b32 s52, s52, 4
    v_alignbit_b32 v61, v61, v60, s52
    v_and_b32 v60, 0xffff, v61
    v_lshrrev_b32 v61, 16, v61
    v_sub_u32 v62, v61, v60
    v_mov_b32 v63, v62
    s_nop 1
    v_add_u32_dpp v63, v63, v63 row_shr:1 row_mask:0xf bank_mask:0xf
    s_nop 1
    v_add_u32_dpp v63, v63, v63 row_shr:2 row_mask:0xf bank_mask:0xf
    s_nop 1
    v_add_u32_dpp v63, v63, v63 row_shr:4 row_mask:0xf bank_mask:0xf
    s_nop 1
    v_add_u32_dpp v63, v63, v63 row_shr:8 row_mask:0xf bank_mask:0xf
    s_nop 1
    v_add_u32_dpp v63, v63, v63 row_bcast:15 row_mask:0xa bank_mask:0xf
    s_nop 1
    v_add_u32_dpp v63, v63, v63 row_bcast:31 row_mask:0xc bank_mask:0xf
    v_sub_u32 v62, v63, v62
    v_sub_u32 v62, v62, v60
    s_lshl_b32 s52, s3, 8
    s_add_u32 s52, s52, 161152
    v_lshlrev_b32 v45, 2, v1
    v_add_u32 v45, s52, v45
    ds_write_b32 v45, v62
    s_lshl_b32 s52, s3, 2
    s_add_u32 s52, s52, 162432
    v_mov_b32 v45, s52
    s_mov_b32 exec_lo, 0
    s_mov_b32 exec_hi, 0x80000000
    ds_write_b32 v45, v63
    s_mov_b64 exec, -1
L2_noscan:
L2_round_bar:
    s_waitcnt lgkmcnt(0)
    s_barrier
    s_cmp_eq_u32 s83, 0
    s_cbranch_scc1 L2_have_tb
    v_lshlrev_b32 v45, 2, v1
    v_add_u32 v45, 162432, v45
    s_mov_b32 exec_lo, 0xff
    s_mov_b32 exec_hi, 0
    ds_read_b32 v46, v45
    s_waitcnt lgkmcnt(0)
    v_max_u32 v46, 1, v46
    v_add_u32 v47, -1, v46
    v_and_b32 v47, 31, v47
    v_cmp_gt_u32 vcc, 16, v47
    v_add_u32 v46, 31, v46
    v_lshrrev_b32 v46, 5, v46
    s_and_b32 s68, vcc_lo, 0x1f
    v_readlane_b32 s52, v46, 0
    v_readlane_b32 s53, v46, 1
    v_readlane_b32 s54, v46, 2
    v_readlane_b32 s55, v46, 3
    v_readlane_b32 s85, v46, 4
    s_mov_b32 s70, s52
    s_add_u32 s71, s70, s53
    s_add_u32 s72, s71, s54
    s_add_u32 s73, s72, s55
    s_add_u32 s67, s73, s85
    s_mov_b32 s74, s67
    s_mov_b32 s85, 0
    v_mov_b32 v46, 0
    s_lshl_b32 s52, s70, 5
    v_writelane_b32 v46, s52, 1
    s_lshl_b32 s52, s71, 5
    v_writelane_b32 v46, s52, 2
    s_lshl_b32 s52, s72, 5
    v_writelane_b32 v46, s52, 3
    s_lshl_b32 s52, s73, 5
    v_writelane_b32 v46, s52, 4
    s_add_u32 s75, s70, 1
    s_add_u32 s76, s71, 1
    s_add_u32 s77, s72, 1
    s_add_u32 s78, s73, 1
    s_mov_b32 s79, 0x7ffffff0
    s_sub_u32 s70, s70, 1
    s_sub_u32 s71, s71, 1
    s_sub_u32 s72, s72, 1
    s_sub_u32 s73, s73, 1
    s_sub_u32 s74, s74, 1
    s_lshl_b32 s52, s3, 5
    s_add_u32 s52, s52, 162464
    v_lshlrev_b32 v45, 2, v1
    v_add_u32 v45, s52, v45
    ds_write_b32 v45, v46
    s_mov_b64 exec, -1
L2_have_tb:
    s_lshl_b32 s52, s3, 5
    s_add_u32 s52, s52, 162464
    v_mov_b32 v59, s52
    s_waitcnt lgkmcnt(0)
    s_waitcnt vmcnt(0)
    v_mov_b32 v58, 0x3f80
    s_mov_b64 exec, s[56:57]
    s_cbranch_execz L2_b0_a0
    v_lshrrev_b32 v44, 17, v32
    v_subrev_u32 v44, s81, v44
    v_lshl_add_u32 v45, v44, 8, v40
    v_add_u32 v45, 161152, v45
    ds_read_b32 v2, v45
    v_lshl_add_u32 v47, v44, 2, v59
    ds_read_b32 v3, v47
L2_b0_a0:
    s_mov_b64 exec, s[58:59]
    s_cbranch_execz L2_b0_a1
    v_lshrrev_b32 v44, 17, v33
    v_subrev_u32 v44, s81, v44
    v_lshl_add_u32 v45, v44, 8, v40
    v_add_u32 v45, 161280, v45
    ds_read_b32 v4, v45
    v_lshl_add_u32 v47, v44, 2, v59
    ds_read_b32 v5, v47
L2_b0_a1:
    s_mov_b64 exec, s[60:61]
    s_cbranch_execz L2_b0_a2
    v_lshrrev_b32 v44, 17, v34
    v_subrev_u32 v44, s81, v44
    v_lshl_add_u32 v45, v44, 8, v40
    v_add_u32 v45, 161152, v45
    ds_read_b32 v6, v45
    v_lshl_add_u32 v47, v44, 2, v59
    ds_read_b32 v7, v47
L2_b0_a2:
    s_mov_b64 exec, s[62:63]
    s_cbranch_execz L2_b0_a3
    v_lshrrev_b32 v44, 17, v35
    v_subrev_u32 v44, s81, v44
    v_lshl_add_u32 v45, v44, 8, v40
    v_add_u32 v45, 161280, v45
    ds_read_b32 v8, v45
    v_lshl_add_u32 v47, v44, 2, v59
    ds_read_b32 v9, v47
L2_b0_a3:
    s_mov_b64 exec, -1
    s_lshl_b32 s53, s66, 5
    s_sub_u32 s52, s82, s53
    v_add_u32 v49, s52, v41
    s_movk_i32 s53, 864
    s_waitcnt lgkmcnt(0)
    s_mov_b64 exec, s[56:57]
    s_cbranch_execz L2_b0_0
    v_add3_u32 v44, v49, v2, v3
    v_add_u32 v44, v44, v223
    v_and_b32 v50, 0x3fff, v32
    v_cmp_gt_u32 vcc, s53, v44
    v_lshlrev_b32 v50, 9, v50
    v_add_u32 v50, 512, v50
    s_and_b64 exec, exec, vcc
    s_cbranch_execz L2_b0_0
    v_lshlrev_b32 v51, 2, v44
    v_add_u32 v51, 69120, v51
    ds_write_b32 v51, v50
    v_lshrrev_b32 v52, 5, v44
    v_mul_u32_u24 v52, 2560, v52
    v_and_b32 v53, 31, v44
    v_lshl_add_u32 v55, v53, 4, v52
    ds_write_b128 v55, v[16:19] offset:2048
    v_bfe_u32 v54, v32, 14, 3
    v_lshl_add_u32 v52, v53, 6, v52
    v_lshl_add_u32 v52, v54, 1, v52
    v_bfe_u32 v53, v53, 2, 2
    v_lshl_add_u32 v54, v53, 4, v52
    ds_write_b16 v54, v58
    v_xor_b32 v55, 1, v53
    v_lshl_add_u32 v55, v55, 4, v52
    ds_write_b16_d16_hi v55, v18
    v_xor_b32 v56, 2, v53
    v_lshl_add_u32 v56, v56, 4, v52
    ds_write_b16 v56, v19
    v_xor_b32 v57, 3, v53
    v_lshl_add_u32 v57, v57, 4, v52
    ds_write_b16_d16_hi v57, v19
L2_b0_0:
    s_mov_b64 exec, s[58:59]
    s_cbranch_execz L2_b0_1
    v_add3_u32 v44, v49, v4, v5
    v_add_u32 v44, v44, v12
    v_and_b32 v50, 0x3fff, v33
    v_cmp_gt_u32 vcc, s53, v44
    v_lshlrev_b32 v50, 9, v50
    v_add_u32 v50, 512, v50
    s_and_b64 exec, exec, vcc
    s_cbranch_execz L2_b0_1
    v_lshlrev_b32 v51, 2, v44
    v_add_u32 v51, 69120, v51
    ds_write_b32 v51, v50
    v_lshrrev_b32 v52, 5, v44
    v_mul_u32_u24 v52, 2560, v52
    v_and_b32 v53, 31, v44
    v_lshl_add_u32 v55, v53, 4, v52
    ds_write_b128 v55, v[20:23] offset:2048
    v_bfe_u32 v54, v33, 14, 3
    v_lshl_add_u32 v52, v53, 6, v52
    v_lshl_add_u32 v52, v54, 1, v52
    v_bfe_u32 v53, v53, 2, 2
    v_lshl_add_u32 v54, v53, 4, v52
    ds_write_b16 v54, v58
    v_xor_b32 v55, 1, v53
    v_lshl_add_u32 v55, v55, 4, v52
    ds_write_b16_d16_hi v55, v22
    v_xor_b32 v56, 2, v53
    v_lshl_add_u32 v56, v56, 4, v52
    ds_write_b16 v56, v23
    v_xor_b32 v57, 3, v53
    v_lshl_add_u32 v57, v57, 4, v52
    ds_write_b16_d16_hi v57, v23
L2_b0_1:
    s_mov_b64 exec, s[60:61]
    s_cbranch_execz L2_b0_2
    v_add3_u32 v44, v49, v6, v7
    v_add_u32 v44, v44, v223
    v_add_u32 v44, 16, v44
    v_and_b32 v50, 0x3fff, v34
    v_cmp_gt_u32 vcc, s53, v44
    v_lshlrev_b32 v50, 9, v50
    v_add_u32 v50, 512, v50
    s_and_b64 exec, exec, vcc
    s_cbranch_execz L2_b0_2
    v_lshlrev_b32 v51, 2, v44
    v_add_u32 v51, 69120, v51
    ds_write_b32 v51, v50
    v_lshrrev_b32 v52, 5, v44
    v_mul_u32_u24 v52, 2560, v52
    v_and_b32 v53, 31, v44
    v_lshl_add_u32 v55, v53, 4, v52
    ds_write_b128 v55, v[24:27] offset:2048
    v_bfe_u32 v54, v34, 14, 3
    v_lshl_add_u32 v52, v53, 6, v52
    v_lshl_add_u32 v52, v54, 1, v52
    v_bfe_u32 v53, v53, 2, 2
    v_lshl_add_u32 v54, v53, 4, v52
    ds_write_b16 v54, v58
    v_xor_b32 v55, 1, v53
    v_lshl_add_u32 v55, v55, 4, v52
    ds_write_b16_d16_hi v55, v26
    v_xor_b32 v56, 2, v53
    v_lshl_add_u32 v56, v56, 4, v52
    ds_write_b16 v56, v27
    v_xor_b32 v57, 3, v53
    v_lshl_add_u32 v57, v57, 4, v52
    ds_write_b16_d16_hi v57, v27
L2_b0_2:
    s_mov_b64 exec, s[62:63]
    s_cbranch_execz L2_b0_3
    v_add3_u32 v44, v49, v8, v9
    v_add_u32 v44, v44, v12
    v_add_u32 v44, 16, v44
    v_and_b32 v50, 0x3fff, v35
    v_cmp_gt_u32 vcc, s53, v44
    v_lshlrev_b32 v50, 9, v50
    v_add_u32 v50, 512, v50
    s_and_b64 exec, exec, vcc
    s_cbranch_execz L2_b0_3
    v_lshlrev_b32 v51, 2, v44
    v_add_u32 v51, 69120, v51
    ds_write_b32 v51, v50
    v_lshrrev_b32 v52, 5, v44
    v_mul_u32_u24 v52, 2560, v52
    v_and_b32 v53, 31, v44
    v_lshl_add_u32 v55, v53, 4, v52
    ds_write_b128 v55, v[28:31] offset:2048
    v_bfe_u32 v54, v35, 14, 3
    v_lshl_add_u32 v52, v53, 6, v52
    v_lshl_add_u32 v52, v54, 1, v52
    v_bfe_u32 v53, v53, 2, 2
    v_lshl_add_u32 v54, v53, 4, v52
    ds_write_b16 v54, v58
    v_xor_b32 v55, 1, v53
    v_lshl_add_u32 v55, v55, 4, v52
    ds_write_b16_d16_hi v55, v30
    v_xor_b32 v56, 2, v53
    v_lshl_add_u32 v56, v56, 4, v52
    ds_write_b16 v56, v31
    v_xor_b32 v57, 3, v53
    v_lshl_add_u32 v57, v57, 4, v52
    ds_write_b16_d16_hi v57, v31
L2_b0_3:
    s_mov_b64 exec, -1
L2_more:
    s_add_u32 s82, s82, 32
    v_cmp_lt_u32 vcc, s82, v224
    v_cmp_lt_u32 s[52:53], s82, v13
    s_or_b64 vcc, vcc, s[52:53]
    s_cbranch_vccz L2_built0
    v_add_u32 v36, s82, v41
    v_cmp_lt_u32 s[56:57], v36, v224
    v_add_u32 v36, v36, v223
    v_lshl_add_u32 v37, v36, 4, v42
    v_lshl_add_u32 v38, v36, 2, v43
    s_mov_b32 s26, 15728640
    s_mov_b32 s27, 18874368
    s_mov_b64 exec, s[56:57]
    s_cbranch_execz L2_ld1_0
    buffer_load_dwordx4 v[16:19], v37, s[28:31], s26 offen sc1
    buffer_load_dword v32, v38, s[28:31], s27 offen sc1
L2_ld1_0:
    s_mov_b64 exec, -1
    v_add_u32 v36, s82, v41
    v_cmp_lt_u32 s[58:59], v36, v13
    v_add_u32 v36, v36, v12
    v_lshl_add_u32 v37, v36, 4, v42
    v_lshl_add_u32 v38, v36, 2, v43
    s_mov_b32 s26, 17104896
    s_mov_b32 s27, 19218432
    s_mov_b64 exec, s[58:59]
    s_cbranch_execz L2_ld1_1
    buffer_load_dwordx4 v[20:23], v37, s[28:31], s26 offen sc1
    buffer_load_dword v33, v38, s[28:31], s27 offen sc1
L2_ld1_1:
    s_mov_b64 exec, -1
    v_add_u32 v36, s82, v41
    v_add_u32 v36, 16, v36
    v_cmp_lt_u32 s[60:61], v36, v224
    v_add_u32 v36, v36, v223
    v_lshl_add_u32 v37, v36, 4, v42
    v_lshl_add_u32 v38, v36, 2, v43
    s_mov_b32 s26, 15728640
    s_mov_b32 s27, 18874368
    s_mov_b64 exec, s[60:61]
    s_cbranch_execz L2_ld1_2
    buffer_load_dwordx4 v[24:27], v37, s[28:31], s26 offen sc1
    buffer_load_dword v34, v38, s[28:31], s27 offen sc1
L2_ld1_2:
    s_mov_b64 exec, -1
    v_add_u32 v36, s82, v41
    v_add_u32 v36, 16, v36
    v_cmp_lt_u32 s[62:63], v36, v13
    v_add_u32 v36, v36, v12
    v_lshl_add_u32 v37, v36, 4, v42
    v_lshl_add_u32 v38, v36, 2, v43
    s_mov_b32 s26, 17104896
    s_mov_b32 s27, 19218432
    s_mov_b64 exec, s[62:63]
    s_cbranch_execz L2_ld1_3
    buffer_load_dwordx4 v[28:31], v37, s[28:31], s26 offen sc1
    buffer_load_dword v35, v38, s[28:31], s27 offen sc1
L2_ld1_3:
    s_mov_b64 exec, -1
    s_waitcnt vmcnt(0)
    v_mov_b32 v58, 0x3f80
    s_mov_b64 exec, s[56:57]
    s_cbranch_execz L2_b1_a0
    v_lshrrev_b32 v44, 17, v32
    v_subrev_u32 v44, s81, v44
    v_lshl_add_u32 v45, v44, 8, v40
    v_add_u32 v45, 161152, v45
    ds_read_b32 v2, v45
    v_lshl_add_u32 v47, v44, 2, v59
    ds_read_b32 v3, v47
L2_b1_a0:
    s_mov_b64 exec, s[58:59]
    s_cbranch_execz L2_b1_a1
    v_lshrrev_b32 v44, 17, v33
    v_subrev_u32 v44, s81, v44
    v_lshl_add_u32 v45, v44, 8, v40
    v_add_u32 v45, 161280, v45
    ds_read_b32 v4, v45
    v_lshl_add_u32 v47, v44, 2, v59
    ds_read_b32 v5, v47
L2_b1_a1:
    s_mov_b64 exec, s[60:61]
    s_cbranch_execz L2_b1_a2
    v_lshrrev_b32 v44, 17, v34
    v_subrev_u32 v44, s81, v44
    v_lshl_add_u32 v45, v44, 8, v40
    v_add_u32 v45, 161152, v45
    ds_read_b32 v6, v45
    v_lshl_add_u32 v47, v44, 2, v59
    ds_read_b32 v7, v47
L2_b1_a2:
    s_mov_b64 exec, s[62:63]
    s_cbranch_execz L2_b1_a3
    v_lshrrev_b32 v44, 17, v35
    v_subrev_u32 v44, s81, v44
    v_lshl_add_u32 v45, v44, 8, v40
    v_add_u32 v45, 161280, v45
    ds_read_b32 v8, v45
    v_lshl_add_u32 v47, v44, 2, v59
    ds_read_b32 v9, v47
L2_b1_a3:
    s_mov_b64 exec, -1
    s_lshl_b32 s53, s66, 5
    s_sub_u32 s52, s82, s53
    v_add_u32 v49, s52, v41
    s_movk_i32 s53, 864
    s_waitcnt lgkmcnt(0)
    s_mov_b64 exec, s[56:57]
    s_cbranch_execz L2_b1_0
    v_add3_u32 v44, v49, v2, v3
    v_add_u32 v44, v44, v223
    v_and_b32 v50, 0x3fff, v32
    v_cmp_gt_u32 vcc, s53, v44
    v_lshlrev_b32 v50, 9, v50
    v_add_u32 v50, 512, v50
    s_and_b64 exec, exec, vcc
    s_cbranch_execz L2_b1_0
    v_lshlrev_b32 v51, 2, v44
    v_add_u32 v51, 69120, v51
    ds_write_b32 v51, v50
    v_lshrrev_b32 v52, 5, v44
    v_mul_u32_u24 v52, 2560, v52
    v_and_b32 v53, 31, v44
    v_lshl_add_u32 v55, v53, 4, v52
    ds_write_b128 v55, v[16:19] offset:2048
    v_bfe_u32 v54, v32, 14, 3
    v_lshl_add_u32 v52, v53, 6, v52
    v_lshl_add_u32 v52, v54, 1, v52
    v_bfe_u32 v53, v53, 2, 2
    v_lshl_add_u32 v54, v53, 4, v52
    ds_write_b16 v54, v58
    v_xor_b32 v55, 1, v53
    v_lshl_add_u32 v55, v55, 4, v52
    ds_write_b16_d16_hi v55, v18
    v_xor_b32 v56, 2, v53
    v_lshl_add_u32 v56, v56, 4, v52
    ds_write_b16 v56, v19
    v_xor_b32 v57, 3, v53
    v_lshl_add_u32 v57, v57, 4, v52
    ds_write_b16_d16_hi v57, v19
L2_b1_0:
    s_mov_b64 exec, s[58:59]
    s_cbranch_execz L2_b1_1
    v_add3_u32 v44, v49, v4, v5
    v_add_u32 v44, v44, v12
    v_and_b32 v50, 0x3fff, v33
    v_cmp_gt_u32 vcc, s53, v44
    v_lshlrev_b32 v50, 9, v50
    v_add_u32 v50, 512, v50
    s_and_b64 exec, exec, vcc
    s_cbranch_execz L2_b1_1
    v_lshlrev_b32 v51, 2, v44
    v_add_u32 v51, 69120, v51
    ds_write_b32 v51, v50
    v_lshrrev_b32 v52, 5, v44
    v_mul_u32_u24 v52, 2560, v52
    v_and_b32 v53, 31, v44
    v_lshl_add_u32 v55, v53, 4, v52
    ds_write_b128 v55, v[20:23] offset:2048
    v_bfe_u32 v54, v33, 14, 3
    v_lshl_add_u32 v52, v53, 6, v52
    v_lshl_add_u32 v52, v54, 1, v52
    v_bfe_u32 v53, v53, 2, 2
    v_lshl_add_u32 v54, v53, 4, v52
    ds_write_b16 v54, v58
    v_xor_b32 v55, 1, v53
    v_lshl_add_u32 v55, v55, 4, v52
    ds_write_b16_d16_hi v55, v22
    v_xor_b32 v56, 2, v53
    v_lshl_add_u32 v56, v56, 4, v52
    ds_write_b16 v56, v23
    v_xor_b32 v57, 3, v53
    v_lshl_add_u32 v57, v57, 4, v52
    ds_write_b16_d16_hi v57, v23
L2_b1_1:
    s_mov_b64 exec, s[60:61]
    s_cbranch_execz L2_b1_2
    v_add3_u32 v44, v49, v6, v7
    v_add_u32 v44, v44, v223
    v_add_u32 v44, 16, v44
    v_and_b32 v50, 0x3fff, v34
    v_cmp_gt_u32 vcc, s53, v44
    v_lshlrev_b32 v50, 9, v50
    v_add_u32 v50, 512, v50
    s_and_b64 exec, exec, vcc
    s_cbranch_execz L2_b1_2
    v_lshlrev_b32 v51, 2, v44
    v_add_u32 v51, 69120, v51
    ds_write_b32 v51, v50
    v_lshrrev_b32 v52, 5, v44
    v_mul_u32_u24 v52, 2560, v52
    v_and_b32 v53, 31, v44
    v_lshl_add_u32 v55, v53, 4, v52
    ds_write_b128 v55, v[24:27] offset:2048
    v_bfe_u32 v54, v34, 14, 3
    v_lshl_add_u32 v52, v53, 6, v52
    v_lshl_add_u32 v52, v54, 1, v52
    v_bfe_u32 v53, v53, 2, 2
    v_lshl_add_u32 v54, v53, 4, v52
    ds_write_b16 v54, v58
    v_xor_b32 v55, 1, v53
    v_lshl_add_u32 v55, v55, 4, v52
    ds_write_b16_d16_hi v55, v26
    v_xor_b32 v56, 2, v53
    v_lshl_add_u32 v56, v56, 4, v52
    ds_write_b16 v56, v27
    v_xor_b32 v57, 3, v53
    v_lshl_add_u32 v57, v57, 4, v52
    ds_write_b16_d16_hi v57, v27
L2_b1_2:
    s_mov_b64 exec, s[62:63]
    s_cbranch_execz L2_b1_3
    v_add3_u32 v44, v49, v8, v9
    v_add_u32 v44, v44, v12
    v_add_u32 v44, 16, v44
    v_and_b32 v50, 0x3fff, v35
    v_cmp_gt_u32 vcc, s53, v44
    v_lshlrev_b32 v50, 9, v50
    v_add_u32 v50, 512, v50
    s_and_b64 exec, exec, vcc
    s_cbranch_execz L2_b1_3
    v_lshlrev_b32 v51, 2, v44
    v_add_u32 v51, 69120, v51
    ds_write_b32 v51, v50
    v_lshrrev_b32 v52, 5, v44
    v_mul_u32_u24 v52, 2560, v52
    v_and_b32 v53, 31, v44
    v_lshl_add_u32 v55, v53, 4, v52
    ds_write_b128 v55, v[28:31] offset:2048
    v_bfe_u32 v54, v35, 14, 3
    v_lshl_add_u32 v52, v53, 6, v52
    v_lshl_add_u32 v52, v54, 1, v52
    v_bfe_u32 v53, v53, 2, 2
    v_lshl_add_u32 v54, v53, 4, v52
    ds_write_b16 v54, v58
    v_xor_b32 v55, 1, v53
    v_lshl_add_u32 v55, v55, 4, v52
    ds_write_b16_d16_hi v55, v30
    v_xor_b32 v56, 2, v53
    v_lshl_add_u32 v56, v56, 4, v52
    ds_write_b16 v56, v31
    v_xor_b32 v57, 3, v53
    v_lshl_add_u32 v57, v57, 4, v52
    ds_write_b16_d16_hi v57, v31
L2_b1_3:
    s_mov_b64 exec, -1
    s_branch L2_more
L2_built0:
    s_cmp_eq_u32 s3, 7
    s_cbranch_scc0 L2_built
    s_cmp_eq_u32 s83, 0
    s_cbranch_scc1 L2_built
    s_add_u32 s44, s20, 21135360
    s_addc_u32 s45, s21, 0
    s_mov_b32 s46, 2048
    s_mov_b32 s47, 0x20000
    s_and_b32 s54, s2, 15
    s_lshl_b32 s54, s54, 7
    s_add_u32 s54, s54, 4
    v_mov_b32 v8, s54
    s_mov_b32 s53, 0x8000
    s_mov_b32 exec_lo, 1
    s_mov_b32 exec_hi, 0
L2_poll2:
    buffer_load_dword v10, v8, s[44:47], 0 offen sc1
    s_waitcnt vmcnt(0)
    v_readfirstlane_b32 s52, v10
    s_and_b32 s52, s52, 0x1
    s_cmp_eq_u32 s52, 0x1
    s_cbranch_scc1 L2_poll2_ok
    s_sub_u32 s53, s53, 1
    s_cmp_eq_u32 s53, 0
    s_cbranch_scc1 L2_poll2_ok
    s_sleep 2
    s_branch L2_poll2
L2_poll2_ok:
    s_mov_b64 exec, -1
L2_built:
    s_waitcnt vmcnt(0) lgkmcnt(0)
    s_barrier
    s_setprio 3
    v_mov_b32 v219, v240
    ds_read2_b32 v[48:49], v219 offset0:0 offset1:16
    ds_read2_b32 v[50:51], v219 offset0:32 offset1:48
    ds_read2_b32 v[52:53], v219 offset0:64 offset1:80
    ds_read2_b32 v[54:55], v219 offset0:96 offset1:112
    ds_read2_b32 v[210:211], v219 offset0:128 offset1:144
    s_cmp_eq_u32 s83, 0
    s_cbranch_scc1 L2_nob2
    s_mov_b32 s32, s20
    s_mov_b32 s33, s21
    s_mov_b32 s34, 5120000
    s_mov_b32 s35, 0x20000
    v_and_b32 v3, 31, v1
    v_lshrrev_b32 v4, 5, v1
    s_lshl_b32 s52, s3, 9
    v_lshlrev_b32 v5, 4, v3
    v_add_u32 v5, s52, v5
    s_lshl_b32 s53, s81, 12
    s_add_u32 s53, s53, -15859712
    v_mul_lo_u32 v6, s53, v4
    v_add_u32 v5, v5, v6
    v_add_u32 v5, 21102592, v5
    v_lshlrev_b32 v6, 12, v4
    buffer_load_dwordx4 v[116:119], v5, s[28:31], 0 offen
L2_nob2:
    s_waitcnt lgkmcnt(1)
    v_add_u32 v48, v48, v220
    s_add_u32 m0, s80, 0
    s_nop 0
    buffer_load_dwordx4 v48, s[32:35], 0 offen lds
    v_add_u32 v49, v49, v220
    s_add_u32 m0, s80, 1024
    s_nop 0
    buffer_load_dwordx4 v49, s[32:35], 0 offen lds
    v_add_u32 v50, v50, v220
    s_add_u32 m0, s80, 2048
    s_nop 0
    buffer_load_dwordx4 v50, s[32:35], 0 offen lds
    v_add_u32 v51, v51, v220
    s_add_u32 m0, s80, 3072
    s_nop 0
    buffer_load_dwordx4 v51, s[32:35], 0 offen lds
    s_sub_u32 s65, s67, s66
    s_min_u32 s65, s65, 27
    s_mov_b32 s64, 0
    s_mov_b32 s69, s66
    v_mov_b32 v216, v225
    v_mov_b32 v217, v226
    v_mov_b32 v218, v227
    v_mov_b32 v80, 0
    v_mov_b32 v81, 0
    v_mov_b32 v82, 0
    v_mov_b32 v83, 0
    v_mov_b32 v84, 0
    v_mov_b32 v85, 0
    v_mov_b32 v86, 0
    v_mov_b32 v87, 0
    v_mov_b32 v244, 0x3e803e80
    v_mov_b32 v245, 0x3e803e80
    v_mov_b32 v246, 0x3e803e80
    v_mov_b32 v247, 0x3e803e80
    v_mov_b32 v100, 0
    v_mov_b32 v101, 0
    v_mov_b32 v102, 0
    v_mov_b32 v103, 0
    v_mov_b32 v104, 0
    v_mov_b32 v105, 0
    v_mov_b32 v106, 0
    v_mov_b32 v107, 0
    s_cmp_eq_u32 s83, 0
    s_cselect_b32 s84, 2, 0
    s_waitcnt vmcnt(2)
    ds_read_b128 v[88:91], v214 offset:0
    ds_read_b128 v[92:95], v215 offset:0
    ds_read_b128 v[96:99], v216 offset:0
    v_add_u32 v52, v52, v220
    s_add_u32 m0, s80, 4096
    s_nop 0
    buffer_load_dwordx4 v52, s[32:35], 0 offen lds
    v_add_u32 v53, v53, v220
    s_add_u32 m0, s80, 5120
    s_nop 0
    buffer_load_dwordx4 v53, s[32:35], 0 offen lds
    v_add_u32 v54, v54, v220
    s_add_u32 m0, s80, 6144
    s_nop 0
    buffer_load_dwordx4 v54, s[32:35], 0 offen lds
    v_add_u32 v55, v55, v220
    s_add_u32 m0, s80, 7168
    s_nop 0
    buffer_load_dwordx4 v55, s[32:35], 0 offen lds
    s_waitcnt lgkmcnt(0)
    v_add_u32 v212, v210, v220
    v_add_u32 v213, v211, v220
    s_add_u32 m0, s80, 0
    s_nop 0
    buffer_load_dwordx4 v212, s[32:35], 0 offen lds
    s_add_u32 m0, s80, 1024
    s_nop 0
    buffer_load_dwordx4 v213, s[32:35], 0 offen lds
    v_mfma_f32_32x32x16_bf16 v[16:31], v[88:91], v[200:203], 0
    v_mfma_f32_32x32x16_bf16 v[16:31], v[92:95], v[204:207], v[16:31]
    v_mfma_f32_32x32x16_bf16 v[16:31], v[96:99], v[116:119], v[16:31]
    ds_read2_b32 v[210:211], v219 offset0:160 offset1:176
    v_add_u32 v219, 768, v219
    s_cmp_eq_u32 s83, 0
    s_cbranch_scc1 L2_nob3
    v_add_u32 v5, v5, v6
    buffer_load_dwordx4 v[120:123], v5, s[28:31], 0 offen
    v_add_u32 v5, v5, v6
    buffer_load_dwordx4 v[124:127], v5, s[28:31], 0 offen
    v_add_u32 v5, v5, v6
    buffer_load_dwordx4 v[128:131], v5, s[28:31], 0 offen
    v_add_u32 v5, v5, v6
    buffer_load_dwordx4 v[132:135], v5, s[28:31], 0 offen
    s_lshl_b32 s52, s3, 6
    s_add_u32 s52, s52, 21106688
    v_lshlrev_b32 v7, 4, v4
    buffer_load_dwordx4 v[108:111], v7, s[28:31], s52 offen
    buffer_load_dwordx4 v[112:115], v7, s[28:31], s52 offen offset:32
    s_waitcnt vmcnt(12)
    s_branch L2_pw3
L2_nob3:
    s_waitcnt vmcnt(6)
L2_pw3:
    s_mov_b32 s83, 0
    ds_read_b128 v[88:91], v214 offset:2048
    ds_read_b128 v[92:95], v215 offset:2048
    ds_read_b128 v[96:99], v216 offset:2560
    s_nop 7
L2_loop:
    s_setprio 3
    s_waitcnt lgkmcnt(0)
    s_cmp_eq_u32 s69, s75
    s_cbranch_scc1 L2_fl_0
L2_fl_0_r:
    s_cmp_eq_u32 s69, s70
    s_cbranch_scc1 L2_rt_0
L2_rt_0_r:
    v_exp_f32 v48, v16
    v_mfma_f32_32x32x16_bf16 v[64:79], v[80:83], v[100:103], v[64:79]
    v_exp_f32 v49, v17
    v_exp_f32 v50, v18
    v_exp_f32 v51, v19
    v_exp_f32 v52, v20
    v_mfma_f32_32x32x16_bf16 v[64:79], v[84:87], v[104:107], v[64:79]
    v_exp_f32 v53, v21
    v_exp_f32 v54, v22
    v_exp_f32 v55, v23
    v_exp_f32 v56, v24
    v_exp_f32 v57, v25
    v_exp_f32 v58, v26
    v_exp_f32 v59, v27
    v_exp_f32 v60, v28
    v_exp_f32 v61, v29
    v_exp_f32 v62, v30
    v_exp_f32 v63, v31
    s_add_u32 s64, s64, 1
    s_add_u32 s69, s69, 1
    v_mfma_f32_32x32x16_bf16 v[48:63], v[244:247], v[244:247], v[48:63]
    ds_read_b64_tr_b16 v[100:101], v217 offset:0
    ds_read_b64_tr_b16 v[102:103], v218 offset:0
    v_add_u32 v212, v210, v220
    s_add_u32 m0, s80, 2048
    v_add_u32 v213, v211, v220
    buffer_load_dwordx4 v212, s[32:35], 0 offen lds
    ds_read_b64_tr_b16 v[104:105], v217 offset:1024
    ds_read_b64_tr_b16 v[106:107], v218 offset:1024
    s_add_u32 m0, s80, 3072
    ds_read2_b32 v[210:211], v219 offset0:0 offset1:16
    buffer_load_dwordx4 v213, s[32:35], 0 offen lds
    s_cmp_eq_u32 s84, 0
    s_cbranch_scc1 L2_wl_0
L2_wl_0_r:
    v_mfma_f32_32x32x16_bf16 v[32:47], v[88:91], v[200:203], 0
    s_cmp_lt_u32 s84, 2
    s_cbranch_scc1 L2_wv_0
    s_waitcnt vmcnt(6)
L2_wv_0_r:
    v_rcp_f32 v48, v48
    v_rcp_f32 v49, v49
    v_rcp_f32 v50, v50
    v_mfma_f32_32x32x16_bf16 v[32:47], v[92:95], v[204:207], v[32:47]
    v_rcp_f32 v51, v51
    v_rcp_f32 v52, v52
    v_rcp_f32 v53, v53
    v_rcp_f32 v54, v54
    v_mfma_f32_32x32x16_bf16 v[32:47], v[96:99], v[116:119], v[32:47]
    v_rcp_f32 v55, v55
    ds_read_b128 v[88:91], v214 offset:4096
    ds_read_b128 v[92:95], v215 offset:4096
    ds_read_b128 v[96:99], v216 offset:5120
    v_rcp_f32 v56, v56
    v_rcp_f32 v57, v57
    v_rcp_f32 v58, v58
    v_rcp_f32 v59, v59
    v_rcp_f32 v60, v60
    v_rcp_f32 v61, v61
    v_rcp_f32 v62, v62
    v_rcp_f32 v63, v63
    v_pk_mul_f32 v[48:49], v[48:49], v[16:17]
    v_pk_mul_f32 v[50:51], v[50:51], v[18:19]
    v_pk_mul_f32 v[52:53], v[52:53], v[20:21]
    v_pk_mul_f32 v[54:55], v[54:55], v[22:23]
    v_pk_mul_f32 v[56:57], v[56:57], v[24:25]
    v_pk_mul_f32 v[58:59], v[58:59], v[26:27]
    v_pk_mul_f32 v[60:61], v[60:61], v[28:29]
    v_pk_mul_f32 v[62:63], v[62:63], v[30:31]
    v_cvt_pk_bf16_f32 v80, v48, v49
    v_cvt_pk_bf16_f32 v81, v50, v51
    v_cvt_pk_bf16_f32 v82, v52, v53
    v_cvt_pk_bf16_f32 v83, v54, v55
    v_cvt_pk_bf16_f32 v84, v56, v57
    v_cvt_pk_bf16_f32 v85, v58, v59
    v_cvt_pk_bf16_f32 v86, v60, v61
    v_cvt_pk_bf16_f32 v87, v62, v63
L2_hf_0_r:
    s_cmp_eq_u32 s64, s65
    s_cbranch_scc1 L2_win_end
    s_setprio 2
    s_waitcnt lgkmcnt(0)
    s_cmp_eq_u32 s69, s75
    s_cbranch_scc1 L2_fl_1
L2_fl_1_r:
    s_cmp_eq_u32 s69, s70
    s_cbranch_scc1 L2_rt_1
L2_rt_1_r:
    v_exp_f32 v48, v32
    v_mfma_f32_32x32x16_bf16 v[64:79], v[80:83], v[100:103], v[64:79]
    v_exp_f32 v49, v33
    v_exp_f32 v50, v34
    v_exp_f32 v51, v35
    v_exp_f32 v52, v36
    v_mfma_f32_32x32x16_bf16 v[64:79], v[84:87], v[104:107], v[64:79]
    v_exp_f32 v53, v37
    v_exp_f32 v54, v38
    v_exp_f32 v55, v39
    v_exp_f32 v56, v40
    v_exp_f32 v57, v41
    v_exp_f32 v58, v42
    v_exp_f32 v59, v43
    v_exp_f32 v60, v44
    v_exp_f32 v61, v45
    v_exp_f32 v62, v46
    v_exp_f32 v63, v47
    s_add_u32 s64, s64, 1
    s_add_u32 s69, s69, 1
    v_mfma_f32_32x32x16_bf16 v[48:63], v[244:247], v[244:247], v[48:63]
    ds_read_b64_tr_b16 v[100:101], v217 offset:2560
    ds_read_b64_tr_b16 v[102:103], v218 offset:2560
    v_add_u32 v212, v210, v220
    s_add_u32 m0, s80, 4096
    v_add_u32 v213, v211, v220
    buffer_load_dwordx4 v212, s[32:35], 0 offen lds
    ds_read_b64_tr_b16 v[104:105], v217 offset:3584
    ds_read_b64_tr_b16 v[106:107], v218 offset:3584
    s_add_u32 m0, s80, 5120
    ds_read2_b32 v[210:211], v219 offset0:32 offset1:48
    buffer_load_dwordx4 v213, s[32:35], 0 offen lds
    s_cmp_eq_u32 s84, 0
    s_cbranch_scc1 L2_wl_1
L2_wl_1_r:
    v_mfma_f32_32x32x16_bf16 v[16:31], v[88:91], v[200:203], 0
    s_cmp_lt_u32 s84, 2
    s_cbranch_scc1 L2_wv_1
    s_waitcnt vmcnt(6)
L2_wv_1_r:
    v_rcp_f32 v48, v48
    v_rcp_f32 v49, v49
    v_rcp_f32 v50, v50
    v_mfma_f32_32x32x16_bf16 v[16:31], v[92:95], v[204:207], v[16:31]
    v_rcp_f32 v51, v51
    v_rcp_f32 v52, v52
    v_rcp_f32 v53, v53
    v_rcp_f32 v54, v54
    v_mfma_f32_32x32x16_bf16 v[16:31], v[96:99], v[116:119], v[16:31]
    v_rcp_f32 v55, v55
    ds_read_b128 v[88:91], v214 offset:6144
    ds_read_b128 v[92:95], v215 offset:6144
    ds_read_b128 v[96:99], v216 offset:7680
    v_rcp_f32 v56, v56
    v_rcp_f32 v57, v57
    v_rcp_f32 v58, v58
    v_rcp_f32 v59, v59
    v_rcp_f32 v60, v60
    v_rcp_f32 v61, v61
    v_rcp_f32 v62, v62
    v_rcp_f32 v63, v63
    v_pk_mul_f32 v[48:49], v[48:49], v[32:33]
    v_pk_mul_f32 v[50:51], v[50:51], v[34:35]
    v_pk_mul_f32 v[52:53], v[52:53], v[36:37]
    v_pk_mul_f32 v[54:55], v[54:55], v[38:39]
    v_pk_mul_f32 v[56:57], v[56:57], v[40:41]
    v_pk_mul_f32 v[58:59], v[58:59], v[42:43]
    v_pk_mul_f32 v[60:61], v[60:61], v[44:45]
    v_pk_mul_f32 v[62:63], v[62:63], v[46:47]
    v_cvt_pk_bf16_f32 v80, v48, v49
    v_cvt_pk_bf16_f32 v81, v50, v51
    v_cvt_pk_bf16_f32 v82, v52, v53
    v_cvt_pk_bf16_f32 v83, v54, v55
    v_cvt_pk_bf16_f32 v84, v56, v57
    v_cvt_pk_bf16_f32 v85, v58, v59
    v_cvt_pk_bf16_f32 v86, v60, v61
    v_cvt_pk_bf16_f32 v87, v62, v63
L2_hf_1_r:
    s_cmp_eq_u32 s64, s65
    s_cbranch_scc1 L2_win_end
    s_setprio 1
    s_waitcnt lgkmcnt(0)
    s_cmp_eq_u32 s69, s75
    s_cbranch_scc1 L2_fl_2
L2_fl_2_r:
    s_cmp_eq_u32 s69, s70
    s_cbranch_scc1 L2_rt_2
L2_rt_2_r:
    v_exp_f32 v48, v16
    v_mfma_f32_32x32x16_bf16 v[64:79], v[80:83], v[100:103], v[64:79]
    v_exp_f32 v49, v17
    v_exp_f32 v50, v18
    v_exp_f32 v51, v19
    v_exp_f32 v52, v20
    v_mfma_f32_32x32x16_bf16 v[64:79], v[84:87], v[104:107], v[64:79]
    v_exp_f32 v53, v21
    v_exp_f32 v54, v22
    v_exp_f32 v55, v23
    v_exp_f32 v56, v24
    v_exp_f32 v57, v25
    v_exp_f32 v58, v26
    v_exp_f32 v59, v27
    v_exp_f32 v60, v28
    v_exp_f32 v61, v29
    v_exp_f32 v62, v30
    v_exp_f32 v63, v31
    s_add_u32 s64, s64, 1
    s_add_u32 s69, s69, 1
    v_mfma_f32_32x32x16_bf16 v[48:63], v[244:247], v[244:247], v[48:63]
    ds_read_b64_tr_b16 v[100:101], v217 offset:5120
    ds_read_b64_tr_b16 v[102:103], v218 offset:5120
    v_add_u32 v212, v210, v220
    s_add_u32 m0, s80, 6144
    v_add_u32 v213, v211, v220
    buffer_load_dwordx4 v212, s[32:35], 0 offen lds
    ds_read_b64_tr_b16 v[104:105], v217 offset:6144
    ds_read_b64_tr_b16 v[106:107], v218 offset:6144
    s_add_u32 m0, s80, 7168
    ds_read2_b32 v[210:211], v219 offset0:64 offset1:80
    buffer_load_dwordx4 v213, s[32:35], 0 offen lds
    s_cmp_eq_u32 s84, 0
    s_cbranch_scc1 L2_wl_2
L2_wl_2_r:
    v_mfma_f32_32x32x16_bf16 v[32:47], v[88:91], v[200:203], 0
    s_cmp_lt_u32 s84, 2
    s_cbranch_scc1 L2_wv_2
    s_waitcnt vmcnt(6)
L2_wv_2_r:
    v_rcp_f32 v48, v48
    v_rcp_f32 v49, v49
    v_rcp_f32 v50, v50
    v_mfma_f32_32x32x16_bf16 v[32:47], v[92:95], v[204:207], v[32:47]
    v_rcp_f32 v51, v51
    v_rcp_f32 v52, v52
    v_rcp_f32 v53, v53
    v_rcp_f32 v54, v54
    v_mfma_f32_32x32x16_bf16 v[32:47], v[96:99], v[116:119], v[32:47]
    v_rcp_f32 v55, v55
    ds_read_b128 v[88:91], v214 offset:0
    ds_read_b128 v[92:95], v215 offset:0
    ds_read_b128 v[96:99], v216 offset:10240
    v_rcp_f32 v56, v56
    v_rcp_f32 v57, v57
    v_rcp_f32 v58, v58
    v_rcp_f32 v59, v59
    v_rcp_f32 v60, v60
    v_rcp_f32 v61, v61
    v_rcp_f32 v62, v62
    v_rcp_f32 v63, v63
    v_pk_mul_f32 v[48:49], v[48:49], v[16:17]
    v_pk_mul_f32 v[50:51], v[50:51], v[18:19]
    v_pk_mul_f32 v[52:53], v[52:53], v[20:21]
    v_pk_mul_f32 v[54:55], v[54:55], v[22:23]
    v_pk_mul_f32 v[56:57], v[56:57], v[24:25]
    v_pk_mul_f32 v[58:59], v[58:59], v[26:27]
    v_pk_mul_f32 v[60:61], v[60:61], v[28:29]
    v_pk_mul_f32 v[62:63], v[62:63], v[30:31]
    v_cvt_pk_bf16_f32 v80, v48, v49
    v_cvt_pk_bf16_f32 v81, v50, v51
    v_cvt_pk_bf16_f32 v82, v52, v53
    v_cvt_pk_bf16_f32 v83, v54, v55
    v_cvt_pk_bf16_f32 v84, v56, v57
    v_cvt_pk_bf16_f32 v85, v58, v59
    v_cvt_pk_bf16_f32 v86, v60, v61
    v_cvt_pk_bf16_f32 v87, v62, v63
L2_hf_2_r:
    s_cmp_eq_u32 s64, s65
    s_cbranch_scc1 L2_win_end
    s_setprio 0
    s_waitcnt lgkmcnt(0)
    s_cmp_eq_u32 s69, s75
    s_cbranch_scc1 L2_fl_3
L2_fl_3_r:
    s_cmp_eq_u32 s69, s70
    s_cbranch_scc1 L2_rt_3
L2_rt_3_r:
    v_exp_f32 v48, v32
    v_mfma_f32_32x32x16_bf16 v[64:79], v[80:83], v[100:103], v[64:79]
    v_exp_f32 v49, v33
    v_exp_f32 v50, v34
    v_exp_f32 v51, v35
    v_exp_f32 v52, v36
    v_mfma_f32_32x32x16_bf16 v[64:79], v[84:87], v[104:107], v[64:79]
    v_exp_f32 v53, v37
    v_exp_f32 v54, v38
    v_exp_f32 v55, v39
    v_exp_f32 v56, v40
    v_exp_f32 v57, v41
    v_exp_f32 v58, v42
    v_exp_f32 v59, v43
    v_exp_f32 v60, v44
    v_exp_f32 v61, v45
    v_exp_f32 v62, v46
    v_exp_f32 v63, v47
    s_add_u32 s64, s64, 1
    s_add_u32 s69, s69, 1
    v_mfma_f32_32x32x16_bf16 v[48:63], v[244:247], v[244:247], v[48:63]
    ds_read_b64_tr_b16 v[100:101], v217 offset:7680
    ds_read_b64_tr_b16 v[102:103], v218 offset:7680
    v_add_u32 v212, v210, v220
    s_add_u32 m0, s80, 0
    v_add_u32 v213, v211, v220
    buffer_load_dwordx4 v212, s[32:35], 0 offen lds
    ds_read_b64_tr_b16 v[104:105], v217 offset:8704
    ds_read_b64_tr_b16 v[106:107], v218 offset:8704
    s_add_u32 m0, s80, 1024
    ds_read2_b32 v[210:211], v219 offset0:96 offset1:112
    buffer_load_dwordx4 v213, s[32:35], 0 offen lds
    s_cmp_eq_u32 s84, 0
    s_cbranch_scc1 L2_wl_3
L2_wl_3_r:
    v_mfma_f32_32x32x16_bf16 v[16:31], v[88:91], v[200:203], 0
    s_cmp_lt_u32 s84, 2
    s_cbranch_scc1 L2_wv_3
    s_waitcnt vmcnt(6)
L2_wv_3_r:
    v_rcp_f32 v48, v48
    v_rcp_f32 v49, v49
    v_rcp_f32 v50, v50
    v_mfma_f32_32x32x16_bf16 v[16:31], v[92:95], v[204:207], v[16:31]
    v_rcp_f32 v51, v51
    v_rcp_f32 v52, v52
    v_rcp_f32 v53, v53
    v_rcp_f32 v54, v54
    v_mfma_f32_32x32x16_bf16 v[16:31], v[96:99], v[116:119], v[16:31]
    v_rcp_f32 v55, v55
    ds_read_b128 v[88:91], v214 offset:2048
    ds_read_b128 v[92:95], v215 offset:2048
    ds_read_b128 v[96:99], v216 offset:12800
    v_rcp_f32 v56, v56
    v_rcp_f32 v57, v57
    v_rcp_f32 v58, v58
    v_rcp_f32 v59, v59
    v_rcp_f32 v60, v60
    v_rcp_f32 v61, v61
    v_rcp_f32 v62, v62
    v_rcp_f32 v63, v63
    v_pk_mul_f32 v[48:49], v[48:49], v[32:33]
    v_pk_mul_f32 v[50:51], v[50:51], v[34:35]
    v_pk_mul_f32 v[52:53], v[52:53], v[36:37]
    v_pk_mul_f32 v[54:55], v[54:55], v[38:39]
    v_pk_mul_f32 v[56:57], v[56:57], v[40:41]
    v_pk_mul_f32 v[58:59], v[58:59], v[42:43]
    v_pk_mul_f32 v[60:61], v[60:61], v[44:45]
    v_pk_mul_f32 v[62:63], v[62:63], v[46:47]
    v_cvt_pk_bf16_f32 v80, v48, v49
    v_cvt_pk_bf16_f32 v81, v50, v51
    v_cvt_pk_bf16_f32 v82, v52, v53
    v_cvt_pk_bf16_f32 v83, v54, v55
    v_cvt_pk_bf16_f32 v84, v56, v57
    v_cvt_pk_bf16_f32 v85, v58, v59
    v_cvt_pk_bf16_f32 v86, v60, v61
    v_cvt_pk_bf16_f32 v87, v62, v63
L2_hf_3_r:
    s_cmp_eq_u32 s64, s65
    s_cbranch_scc1 L2_win_end
    v_add_u32 v216, 10240, v216
    v_add_u32 v217, 10240, v217
    v_add_u32 v218, 10240, v218
    v_add_u32 v219, 512, v219
    s_add_u32 s84, s84, 1
    s_min_u32 s84, s84, 2
    s_branch L2_loop
L2_fl_0:
    s_cmp_eq_u32 s84, 0
    s_cbranch_scc0 L2_flw_0
    s_waitcnt vmcnt(0)
L2_flw_0:
    v_cvt_pk_bf16_f32 v228, v64, v65
    v_cvt_pk_bf16_f32 v229, v66, v67
    v_cvt_pk_bf16_f32 v230, v68, v69
    v_cvt_pk_bf16_f32 v231, v70, v71
    v_cvt_pk_bf16_f32 v232, v72, v73
    v_cvt_pk_bf16_f32 v233, v74, v75
    v_cvt_pk_bf16_f32 v234, v76, v77
    v_cvt_pk_bf16_f32 v235, v78, v79
    s_mov_b64 exec, s[86:87]
    ds_write_b128 v221, v[228:231]
    ds_write_b128 v221, v[232:235] offset:16
    s_mov_b64 exec, -1
    v_mfma_f32_32x32x16_bf16 v[32:47], v[108:111], v[228:231], 0
    v_mfma_f32_32x32x16_bf16 v[32:47], v[112:115], v[232:235], v[32:47]
    v_mfma_f32_32x32x16_bf16 v[64:79], v[236:239], v[236:239], 0
    v_add_u32 v221, 4352, v221
    s_mov_b32 s75, s76
    s_mov_b32 s76, s77
    s_mov_b32 s77, s78
    s_mov_b32 s78, s79
    s_nop 6
    s_mov_b32 exec_hi, 0
    ds_add_f32 v222, v32
    s_mov_b64 exec, -1
    v_add_u32 v222, 128, v222
    s_branch L2_fl_0_r
L2_rt_0:
    s_cmp_eq_u32 s84, 0
    s_cbranch_scc0 L2_rtw_0
    s_waitcnt vmcnt(0)
L2_rtw_0:
    v_pk_mov_b32 v[116:117], v[120:121], v[120:121] op_sel:[0,1]
    v_pk_mov_b32 v[118:119], v[122:123], v[122:123] op_sel:[0,1]
    v_pk_mov_b32 v[120:121], v[124:125], v[124:125] op_sel:[0,1]
    v_pk_mov_b32 v[122:123], v[126:127], v[126:127] op_sel:[0,1]
    v_pk_mov_b32 v[124:125], v[128:129], v[128:129] op_sel:[0,1]
    v_pk_mov_b32 v[126:127], v[130:131], v[130:131] op_sel:[0,1]
    v_pk_mov_b32 v[128:129], v[132:133], v[132:133] op_sel:[0,1]
    v_pk_mov_b32 v[130:131], v[134:135], v[134:135] op_sel:[0,1]
    s_mov_b32 s70, s71
    s_mov_b32 s71, s72
    s_mov_b32 s72, s73
    s_mov_b32 s73, s74
    s_and_b32 s85, s68, 1
    s_lshr_b32 s68, s68, 1
    s_cmp_eq_u32 s85, 1
    s_cbranch_scc0 L2_rt_0_r
    s_branch L2_ha_0
L2_hf_0:
    v_mfma_f32_32x32x16_bf16 v[64:79], v[84:87], v[104:107], v[64:79]
    s_mov_b32 s85, 0
    ds_read_b64_tr_b16 v[104:105], v217 offset:1024
    ds_read_b64_tr_b16 v[106:107], v218 offset:1024
    s_branch L2_hf_0_r
L2_ha_0:
    v_exp_f32 v48, v16
    v_mfma_f32_32x32x16_bf16 v[64:79], v[80:83], v[100:103], v[64:79]
    v_exp_f32 v49, v17
    v_add_u32 v212, v210, v220
    s_add_u32 m0, s80, 2048
    v_exp_f32 v50, v18
    v_add_u32 v213, v211, v220
    buffer_load_dwordx4 v212, s[32:35], 0 offen lds
    v_exp_f32 v51, v19
    ds_read_b64_tr_b16 v[100:101], v217 offset:0
    ds_read_b64_tr_b16 v[102:103], v218 offset:0
    v_exp_f32 v52, v20
    v_mfma_f32_32x32x16_bf16 v[32:47], v[88:91], v[200:203], 0
    v_exp_f32 v53, v21
    s_add_u32 m0, s80, 3072
    v_exp_f32 v54, v22
    buffer_load_dwordx4 v213, s[32:35], 0 offen lds
    v_exp_f32 v55, v23
    s_cmp_eq_u32 s84, 0
    s_cbranch_scc1 L2_wlh_0
L2_wlh_0_r:
    v_pk_add_f32 v[48:49], v[48:49], v[208:209]
    v_pk_add_f32 v[50:51], v[50:51], v[208:209]
    v_pk_add_f32 v[52:53], v[52:53], v[208:209]
    v_pk_add_f32 v[54:55], v[54:55], v[208:209]
    v_rcp_f32 v48, v48
    v_mfma_f32_32x32x16_bf16 v[32:47], v[92:95], v[204:207], v[32:47]
    v_rcp_f32 v49, v49
    s_add_u32 s64, s64, 1
    s_add_u32 s69, s69, 1
    v_rcp_f32 v50, v50
    v_rcp_f32 v51, v51
    v_rcp_f32 v52, v52
    v_mfma_f32_32x32x16_bf16 v[32:47], v[96:99], v[116:119], v[32:47]
    v_rcp_f32 v53, v53
    s_cmp_lt_u32 s84, 2
    s_cbranch_scc1 L2_wvh_0
    s_waitcnt vmcnt(6)
L2_wvh_0_r:
    ds_read_b128 v[88:91], v214 offset:4096
    v_rcp_f32 v54, v54
    ds_read_b128 v[92:95], v215 offset:4096
    ds_read_b128 v[96:99], v216 offset:5120
    v_rcp_f32 v55, v55
    ds_read2_b32 v[210:211], v219 offset0:0 offset1:16
    v_pk_mul_f32 v[48:49], v[48:49], v[16:17]
    v_pk_mul_f32 v[50:51], v[50:51], v[18:19]
    v_pk_mul_f32 v[52:53], v[52:53], v[20:21]
    v_pk_mul_f32 v[54:55], v[54:55], v[22:23]
    v_cvt_pk_bf16_f32 v80, v48, v49
    v_cvt_pk_bf16_f32 v81, v50, v51
    v_cvt_pk_bf16_f32 v82, v52, v53
    v_cvt_pk_bf16_f32 v83, v54, v55
    s_branch L2_hf_0
L2_wl_0:
    v_lshlrev_b32 v5, 4, v1
    s_lshl_b32 s52, s3, 14
    s_add_u32 s52, s52, 20971520
    buffer_load_dwordx4 v[136:139], v5, s[28:31], s52 offen offset:0
    buffer_load_dwordx4 v[140:143], v5, s[28:31], s52 offen offset:1024
    buffer_load_dwordx4 v[144:147], v5, s[28:31], s52 offen offset:2048
    buffer_load_dwordx4 v[148:151], v5, s[28:31], s52 offen offset:3072
    s_branch L2_wl_0_r
L2_wv_0:
    s_cmp_eq_u32 s84, 0
    s_cbranch_scc1 L2_wv_0_0
    s_waitcnt vmcnt(18)
    s_branch L2_wv_0_r
L2_wv_0_0:
    s_waitcnt vmcnt(16)
    s_branch L2_wv_0_r
L2_fl_1:
    s_cmp_eq_u32 s84, 0
    s_cbranch_scc0 L2_flw_1
    s_waitcnt vmcnt(0)
L2_flw_1:
    v_cvt_pk_bf16_f32 v228, v64, v65
    v_cvt_pk_bf16_f32 v229, v66, v67
    v_cvt_pk_bf16_f32 v230, v68, v69
    v_cvt_pk_bf16_f32 v231, v70, v71
    v_cvt_pk_bf16_f32 v232, v72, v73
    v_cvt_pk_bf16_f32 v233, v74, v75
    v_cvt_pk_bf16_f32 v234, v76, v77
    v_cvt_pk_bf16_f32 v235, v78, v79
    s_mov_b64 exec, s[86:87]
    ds_write_b128 v221, v[228:231]
    ds_write_b128 v221, v[232:235] offset:16
    s_mov_b64 exec, -1
    v_mfma_f32_32x32x16_bf16 v[16:31], v[108:111], v[228:231], 0
    v_mfma_f32_32x32x16_bf16 v[16:31], v[112:115], v[232:235], v[16:31]
    v_mfma_f32_32x32x16_bf16 v[64:79], v[236:239], v[236:239], 0
    v_add_u32 v221, 4352, v221
    s_mov_b32 s75, s76
    s_mov_b32 s76, s77
    s_mov_b32 s77, s78
    s_mov_b32 s78, s79
    s_nop 6
    s_mov_b32 exec_hi, 0
    ds_add_f32 v222, v16
    s_mov_b64 exec, -1
    v_add_u32 v222, 128, v222
    s_branch L2_fl_1_r
L2_rt_1:
    s_cmp_eq_u32 s84, 0
    s_cbranch_scc0 L2_rtw_1
    s_waitcnt vmcnt(0)
L2_rtw_1:
    v_pk_mov_b32 v[116:117], v[120:121], v[120:121] op_sel:[0,1]
    v_pk_mov_b32 v[118:119], v[122:123], v[122:123] op_sel:[0,1]
    v_pk_mov_b32 v[120:121], v[124:125], v[124:125] op_sel:[0,1]
    v_pk_mov_b32 v[122:123], v[126:127], v[126:127] op_sel:[0,1]
    v_pk_mov_b32 v[124:125], v[128:129], v[128:129] op_sel:[0,1]
    v_pk_mov_b32 v[126:127], v[130:131], v[130:131] op_sel:[0,1]
    v_pk_mov_b32 v[128:129], v[132:133], v[132:133] op_sel:[0,1]
    v_pk_mov_b32 v[130:131], v[134:135], v[134:135] op_sel:[0,1]
    s_mov_b32 s70, s71
    s_mov_b32 s71, s72
    s_mov_b32 s72, s73
    s_mov_b32 s73, s74
    s_and_b32 s85, s68, 1
    s_lshr_b32 s68, s68, 1
    s_cmp_eq_u32 s85, 1
    s_cbranch_scc0 L2_rt_1_r
    s_branch L2_ha_1
L2_hf_1:
    v_mfma_f32_32x32x16_bf16 v[64:79], v[84:87], v[104:107], v[64:79]
    s_mov_b32 s85, 0
    ds_read_b64_tr_b16 v[104:105], v217 offset:3584
    ds_read_b64_tr_b16 v[106:107], v218 offset:3584
    s_branch L2_hf_1_r
L2_ha_1:
    v_exp_f32 v48, v32
    v_mfma_f32_32x32x16_bf16 v[64:79], v[80:83], v[100:103], v[64:79]
    v_exp_f32 v49, v33
    v_add_u32 v212, v210, v220
    s_add_u32 m0, s80, 4096
    v_exp_f32 v50, v34
    v_add_u32 v213, v211, v220
    buffer_load_dwordx4 v212, s[32:35], 0 offen lds
    v_exp_f32 v51, v35
    ds_read_b64_tr_b16 v[100:101], v217 offset:2560
    ds_read_b64_tr_b16 v[102:103], v218 offset:2560
    v_exp_f32 v52, v36
    v_mfma_f32_32x32x16_bf16 v[16:31], v[88:91], v[200:203], 0
    v_exp_f32 v53, v37
    s_add_u32 m0, s80, 5120
    v_exp_f32 v54, v38
    buffer_load_dwordx4 v213, s[32:35], 0 offen lds
    v_exp_f32 v55, v39
    s_cmp_eq_u32 s84, 0
    s_cbranch_scc1 L2_wlh_1
L2_wlh_1_r:
    v_pk_add_f32 v[48:49], v[48:49], v[208:209]
    v_pk_add_f32 v[50:51], v[50:51], v[208:209]
    v_pk_add_f32 v[52:53], v[52:53], v[208:209]
    v_pk_add_f32 v[54:55], v[54:55], v[208:209]
    v_rcp_f32 v48, v48
    v_mfma_f32_32x32x16_bf16 v[16:31], v[92:95], v[204:207], v[16:31]
    v_rcp_f32 v49, v49
    s_add_u32 s64, s64, 1
    s_add_u32 s69, s69, 1
    v_rcp_f32 v50, v50
    v_rcp_f32 v51, v51
    v_rcp_f32 v52, v52
    v_mfma_f32_32x32x16_bf16 v[16:31], v[96:99], v[116:119], v[16:31]
    v_rcp_f32 v53, v53
    s_cmp_lt_u32 s84, 2
    s_cbranch_scc1 L2_wvh_1
    s_waitcnt vmcnt(6)
L2_wvh_1_r:
    ds_read_b128 v[88:91], v214 offset:6144
    v_rcp_f32 v54, v54
    ds_read_b128 v[92:95], v215 offset:6144
    ds_read_b128 v[96:99], v216 offset:7680
    v_rcp_f32 v55, v55
    ds_read2_b32 v[210:211], v219 offset0:32 offset1:48
    v_pk_mul_f32 v[48:49], v[48:49], v[32:33]
    v_pk_mul_f32 v[50:51], v[50:51], v[34:35]
    v_pk_mul_f32 v[52:53], v[52:53], v[36:37]
    v_pk_mul_f32 v[54:55], v[54:55], v[38:39]
    v_cvt_pk_bf16_f32 v80, v48, v49
    v_cvt_pk_bf16_f32 v81, v50, v51
    v_cvt_pk_bf16_f32 v82, v52, v53
    v_cvt_pk_bf16_f32 v83, v54, v55
    s_branch L2_hf_1
L2_wl_1:
    v_lshlrev_b32 v5, 4, v1
    s_lshl_b32 s52, s3, 14
    s_add_u32 s52, s52, 20975616
    buffer_load_dwordx4 v[152:155], v5, s[28:31], s52 offen offset:0
    buffer_load_dwordx4 v[156:159], v5, s[28:31], s52 offen offset:1024
    buffer_load_dwordx4 v[160:163], v5, s[28:31], s52 offen offset:2048
    buffer_load_dwordx4 v[164:167], v5, s[28:31], s52 offen offset:3072
    s_branch L2_wl_1_r
L2_wv_1:
    s_cmp_eq_u32 s84, 0
    s_cbranch_scc1 L2_wv_1_0
    s_waitcnt vmcnt(14)
    s_branch L2_wv_1_r
L2_wv_1_0:
    s_waitcnt vmcnt(20)
    s_branch L2_wv_1_r
L2_fl_2:
    s_cmp_eq_u32 s84, 0
    s_cbranch_scc0 L2_flw_2
    s_waitcnt vmcnt(0)
L2_flw_2:
    v_cvt_pk_bf16_f32 v228, v64, v65
    v_cvt_pk_bf16_f32 v229, v66, v67
    v_cvt_pk_bf16_f32 v230, v68, v69
    v_cvt_pk_bf16_f32 v231, v70, v71
    v_cvt_pk_bf16_f32 v232, v72, v73
    v_cvt_pk_bf16_f32 v233, v74, v75
    v_cvt_pk_bf16_f32 v234, v76, v77
    v_cvt_pk_bf16_f32 v235, v78, v79
    s_mov_b64 exec, s[86:87]
    ds_write_b128 v221, v[228:231]
    ds_write_b128 v221, v[232:235] offset:16
    s_mov_b64 exec, -1
    v_mfma_f32_32x32x16_bf16 v[32:47], v[108:111], v[228:231], 0
    v_mfma_f32_32x32x16_bf16 v[32:47], v[112:115], v[232:235], v[32:47]
    v_mfma_f32_32x32x16_bf16 v[64:79], v[236:239], v[236:239], 0
    v_add_u32 v221, 4352, v221
    s_mov_b32 s75, s76
    s_mov_b32 s76, s77
    s_mov_b32 s77, s78
    s_mov_b32 s78, s79
    s_nop 6
    s_mov_b32 exec_hi, 0
    ds_add_f32 v222, v32
    s_mov_b64 exec, -1
    v_add_u32 v222, 128, v222
    s_branch L2_fl_2_r
L2_rt_2:
    s_cmp_eq_u32 s84, 0
    s_cbranch_scc0 L2_rtw_2
    s_waitcnt vmcnt(0)
L2_rtw_2:
    v_pk_mov_b32 v[116:117], v[120:121], v[120:121] op_sel:[0,1]
    v_pk_mov_b32 v[118:119], v[122:123], v[122:123] op_sel:[0,1]
    v_pk_mov_b32 v[120:121], v[124:125], v[124:125] op_sel:[0,1]
    v_pk_mov_b32 v[122:123], v[126:127], v[126:127] op_sel:[0,1]
    v_pk_mov_b32 v[124:125], v[128:129], v[128:129] op_sel:[0,1]
    v_pk_mov_b32 v[126:127], v[130:131], v[130:131] op_sel:[0,1]
    v_pk_mov_b32 v[128:129], v[132:133], v[132:133] op_sel:[0,1]
    v_pk_mov_b32 v[130:131], v[134:135], v[134:135] op_sel:[0,1]
    s_mov_b32 s70, s71
    s_mov_b32 s71, s72
    s_mov_b32 s72, s73
    s_mov_b32 s73, s74
    s_and_b32 s85, s68, 1
    s_lshr_b32 s68, s68, 1
    s_cmp_eq_u32 s85, 1
    s_cbranch_scc0 L2_rt_2_r
    s_branch L2_ha_2
L2_hf_2:
    v_mfma_f32_32x32x16_bf16 v[64:79], v[84:87], v[104:107], v[64:79]
    s_mov_b32 s85, 0
    ds_read_b64_tr_b16 v[104:105], v217 offset:6144
    ds_read_b64_tr_b16 v[106:107], v218 offset:6144
    s_branch L2_hf_2_r
L2_ha_2:
    v_exp_f32 v48, v16
    v_mfma_f32_32x32x16_bf16 v[64:79], v[80:83], v[100:103], v[64:79]
    v_exp_f32 v49, v17
    v_add_u32 v212, v210, v220
    s_add_u32 m0, s80, 6144
    v_exp_f32 v50, v18
    v_add_u32 v213, v211, v220
    buffer_load_dwordx4 v212, s[32:35], 0 offen lds
    v_exp_f32 v51, v19
    ds_read_b64_tr_b16 v[100:101], v217 offset:5120
    ds_read_b64_tr_b16 v[102:103], v218 offset:5120
    v_exp_f32 v52, v20
    v_mfma_f32_32x32x16_bf16 v[32:47], v[88:91], v[200:203], 0
    v_exp_f32 v53, v21
    s_add_u32 m0, s80, 7168
    v_exp_f32 v54, v22
    buffer_load_dwordx4 v213, s[32:35], 0 offen lds
    v_exp_f32 v55, v23
    s_cmp_eq_u32 s84, 0
    s_cbranch_scc1 L2_wlh_2
L2_wlh_2_r:
    v_pk_add_f32 v[48:49], v[48:49], v[208:209]
    v_pk_add_f32 v[50:51], v[50:51], v[208:209]
    v_pk_add_f32 v[52:53], v[52:53], v[208:209]
    v_pk_add_f32 v[54:55], v[54:55], v[208:209]
    v_rcp_f32 v48, v48
    v_mfma_f32_32x32x16_bf16 v[32:47], v[92:95], v[204:207], v[32:47]
    v_rcp_f32 v49, v49
    s_add_u32 s64, s64, 1
    s_add_u32 s69, s69, 1
    v_rcp_f32 v50, v50
    v_rcp_f32 v51, v51
    v_rcp_f32 v52, v52
    v_mfma_f32_32x32x16_bf16 v[32:47], v[96:99], v[116:119], v[32:47]
    v_rcp_f32 v53, v53
    s_cmp_lt_u32 s84, 2
    s_cbranch_scc1 L2_wvh_2
    s_waitcnt vmcnt(6)
L2_wvh_2_r:
    ds_read_b128 v[88:91], v214 offset:0
    v_rcp_f32 v54, v54
    ds_read_b128 v[92:95], v215 offset:0
    ds_read_b128 v[96:99], v216 offset:10240
    v_rcp_f32 v55, v55
    ds_read2_b32 v[210:211], v219 offset0:64 offset1:80
    v_pk_mul_f32 v[48:49], v[48:49], v[16:17]
    v_pk_mul_f32 v[50:51], v[50:51], v[18:19]
    v_pk_mul_f32 v[52:53], v[52:53], v[20:21]
    v_pk_mul_f32 v[54:55], v[54:55], v[22:23]
    v_cvt_pk_bf16_f32 v80, v48, v49
    v_cvt_pk_bf16_f32 v81, v50, v51
    v_cvt_pk_bf16_f32 v82, v52, v53
    v_cvt_pk_bf16_f32 v83, v54, v55
    s_branch L2_hf_2
L2_wl_2:
    v_lshlrev_b32 v5, 4, v1
    s_lshl_b32 s52, s3, 14
    s_add_u32 s52, s52, 20979712
    buffer_load_dwordx4 v[168:171], v5, s[28:31], s52 offen offset:0
    buffer_load_dwordx4 v[172:175], v5, s[28:31], s52 offen offset:1024
    buffer_load_dwordx4 v[176:179], v5, s[28:31], s52 offen offset:2048
    buffer_load_dwordx4 v[180:183], v5, s[28:31], s52 offen offset:3072
    s_branch L2_wl_2_r
L2_wv_2:
    s_cmp_eq_u32 s84, 0
    s_cbranch_scc1 L2_wv_2_0
    s_waitcnt vmcnt(10)
    s_branch L2_wv_2_r
L2_wv_2_0:
    s_waitcnt vmcnt(24)
    s_branch L2_wv_2_r
L2_fl_3:
    s_cmp_eq_u32 s84, 0
    s_cbranch_scc0 L2_flw_3
    s_waitcnt vmcnt(0)
L2_flw_3:
    v_cvt_pk_bf16_f32 v228, v64, v65
    v_cvt_pk_bf16_f32 v229, v66, v67
    v_cvt_pk_bf16_f32 v230, v68, v69
    v_cvt_pk_bf16_f32 v231, v70, v71
    v_cvt_pk_bf16_f32 v232, v72, v73
    v_cvt_pk_bf16_f32 v233, v74, v75
    v_cvt_pk_bf16_f32 v234, v76, v77
    v_cvt_pk_bf16_f32 v235, v78, v79
    s_mov_b64 exec, s[86:87]
    ds_write_b128 v221, v[228:231]
    ds_write_b128 v221, v[232:235] offset:16
    s_mov_b64 exec, -1
    v_mfma_f32_32x32x16_bf16 v[16:31], v[108:111], v[228:231], 0
    v_mfma_f32_32x32x16_bf16 v[16:31], v[112:115], v[232:235], v[16:31]
    v_mfma_f32_32x32x16_bf16 v[64:79], v[236:239], v[236:239], 0
    v_add_u32 v221, 4352, v221
    s_mov_b32 s75, s76
    s_mov_b32 s76, s77
    s_mov_b32 s77, s78
    s_mov_b32 s78, s79
    s_nop 6
    s_mov_b32 exec_hi, 0
    ds_add_f32 v222, v16
    s_mov_b64 exec, -1
    v_add_u32 v222, 128, v222
    s_branch L2_fl_3_r
L2_rt_3:
    s_cmp_eq_u32 s84, 0
    s_cbranch_scc0 L2_rtw_3
    s_waitcnt vmcnt(0)
L2_rtw_3:
    v_pk_mov_b32 v[116:117], v[120:121], v[120:121] op_sel:[0,1]
    v_pk_mov_b32 v[118:119], v[122:123], v[122:123] op_sel:[0,1]
    v_pk_mov_b32 v[120:121], v[124:125], v[124:125] op_sel:[0,1]
    v_pk_mov_b32 v[122:123], v[126:127], v[126:127] op_sel:[0,1]
    v_pk_mov_b32 v[124:125], v[128:129], v[128:129] op_sel:[0,1]
    v_pk_mov_b32 v[126:127], v[130:131], v[130:131] op_sel:[0,1]
    v_pk_mov_b32 v[128:129], v[132:133], v[132:133] op_sel:[0,1]
    v_pk_mov_b32 v[130:131], v[134:135], v[134:135] op_sel:[0,1]
    s_mov_b32 s70, s71
    s_mov_b32 s71, s72
    s_mov_b32 s72, s73
    s_mov_b32 s73, s74
    s_and_b32 s85, s68, 1
    s_lshr_b32 s68, s68, 1
    s_cmp_eq_u32 s85, 1
    s_cbranch_scc0 L2_rt_3_r
    s_branch L2_ha_3
L2_hf_3:
    v_mfma_f32_32x32x16_bf16 v[64:79], v[84:87], v[104:107], v[64:79]
    s_mov_b32 s85, 0
    ds_read_b64_tr_b16 v[104:105], v217 offset:8704
    ds_read_b64_tr_b16 v[106:107], v218 offset:8704
    s_branch L2_hf_3_r
L2_ha_3:
    v_exp_f32 v48, v32
    v_mfma_f32_32x32x16_bf16 v[64:79], v[80:83], v[100:103], v[64:79]
    v_exp_f32 v49, v33
    v_add_u32 v212, v210, v220
    s_add_u32 m0, s80, 0
    v_exp_f32 v50, v34
    v_add_u32 v213, v211, v220
    buffer_load_dwordx4 v212, s[32:35], 0 offen lds
    v_exp_f32 v51, v35
    ds_read_b64_tr_b16 v[100:101], v217 offset:7680
    ds_read_b64_tr_b16 v[102:103], v218 offset:7680
    v_exp_f32 v52, v36
    v_mfma_f32_32x32x16_bf16 v[16:31], v[88:91], v[200:203], 0
    v_exp_f32 v53, v37
    s_add_u32 m0, s80, 1024
    v_exp_f32 v54, v38
    buffer_load_dwordx4 v213, s[32:35], 0 offen lds
    v_exp_f32 v55, v39
    s_cmp_eq_u32 s84, 0
    s_cbranch_scc1 L2_wlh_3
L2_wlh_3_r:
    v_pk_add_f32 v[48:49], v[48:49], v[208:209]
    v_pk_add_f32 v[50:51], v[50:51], v[208:209]
    v_pk_add_f32 v[52:53], v[52:53], v[208:209]
    v_pk_add_f32 v[54:55], v[54:55], v[208:209]
    v_rcp_f32 v48, v48
    v_mfma_f32_32x32x16_bf16 v[16:31], v[92:95], v[204:207], v[16:31]
    v_rcp_f32 v49, v49
    s_add_u32 s64, s64, 1
    s_add_u32 s69, s69, 1
    v_rcp_f32 v50, v50
    v_rcp_f32 v51, v51
    v_rcp_f32 v52, v52
    v_mfma_f32_32x32x16_bf16 v[16:31], v[96:99], v[116:119], v[16:31]
    v_rcp_f32 v53, v53
    s_cmp_lt_u32 s84, 2
    s_cbranch_scc1 L2_wvh_3
    s_waitcnt vmcnt(6)
L2_wvh_3_r:
    ds_read_b128 v[88:91], v214 offset:2048
    v_rcp_f32 v54, v54
    ds_read_b128 v[92:95], v215 offset:2048
    ds_read_b128 v[96:99], v216 offset:12800
    v_rcp_f32 v55, v55
    ds_read2_b32 v[210:211], v219 offset0:96 offset1:112
    v_pk_mul_f32 v[48:49], v[48:49], v[32:33]
    v_pk_mul_f32 v[50:51], v[50:51], v[34:35]
    v_pk_mul_f32 v[52:53], v[52:53], v[36:37]
    v_pk_mul_f32 v[54:55], v[54:55], v[38:39]
    v_cvt_pk_bf16_f32 v80, v48, v49
    v_cvt_pk_bf16_f32 v81, v50, v51
    v_cvt_pk_bf16_f32 v82, v52, v53
    v_cvt_pk_bf16_f32 v83, v54, v55
    s_branch L2_hf_3
L2_wl_3:
    v_lshlrev_b32 v5, 4, v1
    s_lshl_b32 s52, s3, 14
    s_add_u32 s52, s52, 20983808
    buffer_load_dwordx4 v[184:187], v5, s[28:31], s52 offen offset:0
    buffer_load_dwordx4 v[188:191], v5, s[28:31], s52 offen offset:1024
    buffer_load_dwordx4 v[192:195], v5, s[28:31], s52 offen offset:2048
    buffer_load_dwordx4 v[196:199], v5, s[28:31], s52 offen offset:3072
    s_branch L2_wl_3_r
L2_wv_3:
    s_cmp_eq_u32 s84, 0
    s_cbranch_scc1 L2_wv_3_0
    s_waitcnt vmcnt(6)
    s_branch L2_wv_3_r
L2_wv_3_0:
    s_waitcnt vmcnt(22)
    s_branch L2_wv_3_r
L2_wlh_0:
    v_lshlrev_b32 v5, 4, v1
    s_lshl_b32 s52, s3, 14
    s_add_u32 s52, s52, 20971520
    buffer_load_dwordx4 v[136:139], v5, s[28:31], s52 offen offset:0
    buffer_load_dwordx4 v[140:143], v5, s[28:31], s52 offen offset:1024
    buffer_load_dwordx4 v[144:147], v5, s[28:31], s52 offen offset:2048
    buffer_load_dwordx4 v[148:151], v5, s[28:31], s52 offen offset:3072
    s_branch L2_wlh_0_r
L2_wvh_0:
    s_cmp_eq_u32 s84, 0
    s_cbranch_scc1 L2_wvh_0_0
    s_waitcnt vmcnt(18)
    s_branch L2_wvh_0_r
L2_wvh_0_0:
    s_waitcnt vmcnt(16)
    s_branch L2_wvh_0_r
L2_wlh_1:
    v_lshlrev_b32 v5, 4, v1
    s_lshl_b32 s52, s3, 14
    s_add_u32 s52, s52, 20975616
    buffer_load_dwordx4 v[152:155], v5, s[28:31], s52 offen offset:0
    buffer_load_dwordx4 v[156:159], v5, s[28:31], s52 offen offset:1024
    buffer_load_dwordx4 v[160:163], v5, s[28:31], s52 offen offset:2048
    buffer_load_dwordx4 v[164:167], v5, s[28:31], s52 offen offset:3072
    s_branch L2_wlh_1_r
L2_wvh_1:
    s_cmp_eq_u32 s84, 0
    s_cbranch_scc1 L2_wvh_1_0
    s_waitcnt vmcnt(14)
    s_branch L2_wvh_1_r
L2_wvh_1_0:
    s_waitcnt vmcnt(20)
    s_branch L2_wvh_1_r
L2_wlh_2:
    v_lshlrev_b32 v5, 4, v1
    s_lshl_b32 s52, s3, 14
    s_add_u32 s52, s52, 20979712
    buffer_load_dwordx4 v[168:171], v5, s[28:31], s52 offen offset:0
    buffer_load_dwordx4 v[172:175], v5, s[28:31], s52 offen offset:1024
    buffer_load_dwordx4 v[176:179], v5, s[28:31], s52 offen offset:2048
    buffer_load_dwordx4 v[180:183], v5, s[28:31], s52 offen offset:3072
    s_branch L2_wlh_2_r
L2_wvh_2:
    s_cmp_eq_u32 s84, 0
    s_cbranch_scc1 L2_wvh_2_0
    s_waitcnt vmcnt(10)
    s_branch L2_wvh_2_r
L2_wvh_2_0:
    s_waitcnt vmcnt(24)
    s_branch L2_wvh_2_r
L2_wlh_3:
    v_lshlrev_b32 v5, 4, v1
    s_lshl_b32 s52, s3, 14
    s_add_u32 s52, s52, 20983808
    buffer_load_dwordx4 v[184:187], v5, s[28:31], s52 offen offset:0
    buffer_load_dwordx4 v[188:191], v5, s[28:31], s52 offen offset:1024
    buffer_load_dwordx4 v[192:195], v5, s[28:31], s52 offen offset:2048
    buffer_load_dwordx4 v[196:199], v5, s[28:31], s52 offen offset:3072
    s_branch L2_wlh_3_r
L2_wvh_3:
    s_cmp_eq_u32 s84, 0
    s_cbranch_scc1 L2_wvh_3_0
    s_waitcnt vmcnt(6)
    s_branch L2_wvh_3_r
L2_wvh_3_0:
    s_waitcnt vmcnt(22)
    s_branch L2_wvh_3_r
L2_win_end:
    s_setprio 0
    s_waitcnt lgkmcnt(0)
    s_cmp_eq_u32 s69, s75
    s_cbranch_scc0 L2_we_nf
    s_nop 3
    v_cvt_pk_bf16_f32 v228, v64, v65
    v_cvt_pk_bf16_f32 v229, v66, v67
    v_cvt_pk_bf16_f32 v230, v68, v69
    v_cvt_pk_bf16_f32 v231, v70, v71
    v_cvt_pk_bf16_f32 v232, v72, v73
    v_cvt_pk_bf16_f32 v233, v74, v75
    v_cvt_pk_bf16_f32 v234, v76, v77
    v_cvt_pk_bf16_f32 v235, v78, v79
    s_mov_b64 exec, s[86:87]
    ds_write_b128 v221, v[228:231]
    ds_write_b128 v221, v[232:235] offset:16
    s_mov_b64 exec, -1
    v_mfma_f32_32x32x16_bf16 v[16:31], v[108:111], v[228:231], 0
    v_mfma_f32_32x32x16_bf16 v[16:31], v[112:115], v[232:235], v[16:31]
    v_mfma_f32_32x32x16_bf16 v[64:79], v[236:239], v[236:239], 0
    v_add_u32 v221, 4352, v221
    s_mov_b32 s75, s76
    s_mov_b32 s76, s77
    s_mov_b32 s77, s78
    s_mov_b32 s78, s79
    s_nop 6
    s_mov_b32 exec_hi, 0
    ds_add_f32 v222, v16
    s_mov_b64 exec, -1
    v_add_u32 v222, 128, v222
L2_we_nf:
    v_mfma_f32_32x32x16_bf16 v[64:79], v[80:83], v[100:103], v[64:79]
    v_mfma_f32_32x32x16_bf16 v[64:79], v[84:87], v[104:107], v[64:79]
    s_add_u32 s66, s66, s65
    s_cmp_ge_u32 s66, s67
    s_cbranch_scc1 L2_final
    s_waitcnt vmcnt(0) lgkmcnt(0)
    s_barrier
    s_mov_b32 s82, 0
    v_mov_b32 v36, 0
    v_mov_b32 v37, 0
    v_mov_b32 v38, 0
    v_mov_b32 v39, 0
    v_lshlrev_b32 v40, 4, v0
    v_add_u32 v41, 0x10000, v40
    ds_write_b128 v40, v[36:39] offset:0
    ds_write_b128 v40, v[36:39] offset:8192
    ds_write_b128 v40, v[36:39] offset:16384
    ds_write_b128 v40, v[36:39] offset:24576
    ds_write_b128 v40, v[36:39] offset:32768
    ds_write_b128 v40, v[36:39] offset:40960
    ds_write_b128 v40, v[36:39] offset:49152
    ds_write_b128 v40, v[36:39] offset:57344
    ds_write_b128 v41, v[36:39]
    v_lshrrev_b32 v44, 4, v1
    s_lshl_b32 s52, s3, 2
    v_add_u32 v44, s52, v44
    s_mov_b32 s52, 43008
    v_mul_lo_u32 v42, s52, v44
    s_movk_i32 s52, 10752
    v_mul_lo_u32 v43, s52, v44
    v_lshlrev_b32 v40, 2, v44
    v_and_b32 v41, 15, v1
    v_add_u32 v36, s82, v41
    v_cmp_lt_u32 s[56:57], v36, v224
    v_add_u32 v36, v36, v223
    v_lshl_add_u32 v37, v36, 4, v42
    v_lshl_add_u32 v38, v36, 2, v43
    s_mov_b32 s26, 15728640
    s_mov_b32 s27, 18874368
    s_mov_b64 exec, s[56:57]
    s_cbranch_execz L2_ld2_0
    buffer_load_dwordx4 v[16:19], v37, s[28:31], s26 offen sc1
    buffer_load_dword v32, v38, s[28:31], s27 offen sc1
L2_ld2_0:
    s_mov_b64 exec, -1
    v_add_u32 v36, s82, v41
    v_cmp_lt_u32 s[58:59], v36, v13
    v_add_u32 v36, v36, v12
    v_lshl_add_u32 v37, v36, 4, v42
    v_lshl_add_u32 v38, v36, 2, v43
    s_mov_b32 s26, 17104896
    s_mov_b32 s27, 19218432
    s_mov_b64 exec, s[58:59]
    s_cbranch_execz L2_ld2_1
    buffer_load_dwordx4 v[20:23], v37, s[28:31], s26 offen sc1
    buffer_load_dword v33, v38, s[28:31], s27 offen sc1
L2_ld2_1:
    s_mov_b64 exec, -1
    v_add_u32 v36, s82, v41
    v_add_u32 v36, 16, v36
    v_cmp_lt_u32 s[60:61], v36, v224
    v_add_u32 v36, v36, v223
    v_lshl_add_u32 v37, v36, 4, v42
    v_lshl_add_u32 v38, v36, 2, v43
    s_mov_b32 s26, 15728640
    s_mov_b32 s27, 18874368
    s_mov_b64 exec, s[60:61]
    s_cbranch_execz L2_ld2_2
    buffer_load_dwordx4 v[24:27], v37, s[28:31], s26 offen sc1
    buffer_load_dword v34, v38, s[28:31], s27 offen sc1
L2_ld2_2:
    s_mov_b64 exec, -1
    v_add_u32 v36, s82, v41
    v_add_u32 v36, 16, v36
    v_cmp_lt_u32 s[62:63], v36, v13
    v_add_u32 v36, v36, v12
    v_lshl_add_u32 v37, v36, 4, v42
    v_lshl_add_u32 v38, v36, 2, v43
    s_mov_b32 s26, 17104896
    s_mov_b32 s27, 19218432
    s_mov_b64 exec, s[62:63]
    s_cbranch_execz L2_ld2_3
    buffer_load_dwordx4 v[28:31], v37, s[28:31], s26 offen sc1
    buffer_load_dword v35, v38, s[28:31], s27 offen sc1
L2_ld2_3:
    s_mov_b64 exec, -1
    s_branch L2_round_bar
L2_final:
    s_cmp_ge_u32 s67, 8
    s_cbranch_scc1 L2_wh_done
    s_waitcnt vmcnt(0)
L2_wh_done:
    s_mov_b32 s36, s4
    s_mov_b32 s37, s5
    s_mov_b32 s38, 5120000
    s_mov_b32 s39, 0x20000
    s_mov_b32 s40, s22
    s_mov_b32 s41, s23
    s_mov_b32 s42, 5120000
    s_mov_b32 s43, 0x20000
    s_mov_b32 s44, s6
    s_mov_b32 s45, s7
    s_mov_b32 s46, 60000
    s_mov_b32 s47, 0x20000
    s_add_u32 s48, s22, 5120000
    s_addc_u32 s49, s23, 0
    s_mov_b32 s50, 60000
    s_mov_b32 s51, 0x20000
    v_and_b32 v3, 15, v1
    v_lshrrev_b32 v4, 4, v1
    v_lshrrev_b32 v5, 3, v3
    v_lshlrev_b32 v5, 12, v5
    v_and_b32 v6, 7, v3
    v_lshl_add_u32 v5, v6, 4, v5
    v_lshl_add_u32 v5, v4, 7, v5
    s_lshl_b32 s52, s3, 9
    v_add_u32 v5, s52, v5
    s_lshl_b32 s56, s81, 12
    s_add_u32 s56, s56, 10485760
    v_lshlrev_b32 v6, 9, v3
    v_lshl_add_u32 v6, v4, 4, v6
    s_lshl_b32 s52, s3, 6
    v_add_u32 v6, s52, v6
    s_mul_i32 s57, s2, 20480
    v_bfe_u32 v10, v1, 3, 1
    v_mul_u32_u24 v10, 4088, v10
    v_sub_u32 v11, v5, v10
    v_sub_u32 v10, v6, v10
    buffer_load_dwordx4 v[88:91], v5, s[28:31], s56 offen
    s_add_u32 s56, s56, 8192
    buffer_load_dwordx4 v[92:95], v5, s[28:31], s56 offen
    s_add_u32 s56, s56, 8192
    buffer_load_dwordx2 v[96:97], v11, s[28:31], s56 offen
    s_add_u32 s58, s57, 0
    buffer_load_dwordx4 v[120:123], v6, s[36:39], s58 offen
    s_add_u32 s58, s57, 8192
    buffer_load_dwordx4 v[124:127], v6, s[36:39], s58 offen
    s_add_u32 s58, s57, 16384
    buffer_load_dwordx2 v[128:129], v10, s[36:39], s58 offen
    v_lshlrev_b32 v7, 2, v1
    s_mul_i32 s59, s2, 240
    buffer_load_dword v8, v7, s[44:47], s59 offen
    v_cvt_pk_bf16_f32 v228, v64, v65
    v_cvt_pk_bf16_f32 v229, v66, v67
    v_cvt_pk_bf16_f32 v230, v68, v69
    v_cvt_pk_bf16_f32 v231, v70, v71
    v_cvt_pk_bf16_f32 v232, v72, v73
    v_cvt_pk_bf16_f32 v233, v74, v75
    v_cvt_pk_bf16_f32 v234, v76, v77
    v_cvt_pk_bf16_f32 v235, v78, v79
    s_mov_b64 exec, s[86:87]
    ds_write_b128 v221, v[228:231]
    ds_write_b128 v221, v[232:235] offset:16
    s_mov_b64 exec, -1
    v_mfma_f32_32x32x16_bf16 v[32:47], v[108:111], v[228:231], 0
    v_mfma_f32_32x32x16_bf16 v[32:47], v[112:115], v[232:235], v[32:47]
    v_mfma_f32_32x32x16_bf16 v[64:79], v[236:239], v[236:239], 0
    v_add_u32 v221, 4352, v221
    s_mov_b32 s75, s76
    s_mov_b32 s76, s77
    s_mov_b32 s77, s78
    s_mov_b32 s78, s79
    s_nop 6
    s_mov_b32 exec_hi, 0
    ds_add_f32 v222, v32
    s_mov_b64 exec, -1
    v_add_u32 v222, 128, v222
    v_mul_u32_u24 v9, 544, v3
    v_lshl_add_u32 v9, v4, 4, v9
    v_add_u32 v9, 138752, v9
    s_waitcnt lgkmcnt(0)
    s_barrier
    s_mov_b32 s60, 0xffff0000
    s_mov_b32 s61, 0xbf317218
    ds_read_b128 v[40:43], v9 offset:0
    ds_read_b128 v[44:47], v9 offset:64
    ds_read_b128 v[48:51], v9 offset:128
    ds_read_b128 v[52:55], v9 offset:192
    ds_read_b128 v[56:59], v9 offset:256
    s_waitcnt lgkmcnt(4)
    v_mfma_f32_16x16x32_bf16 v[16:19], v[136:139], v[40:43], 0
    v_mfma_f32_16x16x32_bf16 v[20:23], v[168:171], v[40:43], 0
    ds_read_b128 v[60:63], v9 offset:320
    s_waitcnt lgkmcnt(4)
    v_mfma_f32_16x16x32_bf16 v[16:19], v[140:143], v[44:47], v[16:19]
    v_mfma_f32_16x16x32_bf16 v[20:23], v[172:175], v[44:47], v[20:23]
    ds_read_b128 v[40:43], v9 offset:384
    s_waitcnt lgkmcnt(4)
    v_mfma_f32_16x16x32_bf16 v[16:19], v[144:147], v[48:51], v[16:19]
    v_mfma_f32_16x16x32_bf16 v[20:23], v[176:179], v[48:51], v[20:23]
    ds_read_b128 v[44:47], v9 offset:448
    s_waitcnt lgkmcnt(4)
    v_mfma_f32_16x16x32_bf16 v[16:19], v[148:151], v[52:55], v[16:19]
    v_mfma_f32_16x16x32_bf16 v[20:23], v[180:183], v[52:55], v[20:23]
    ds_read_b128 v[48:51], v9 offset:8704
    s_waitcnt lgkmcnt(4)
    v_mfma_f32_16x16x32_bf16 v[16:19], v[152:155], v[56:59], v[16:19]
    v_mfma_f32_16x16x32_bf16 v[20:23], v[184:187], v[56:59], v[20:23]
    ds_read_b128 v[52:55], v9 offset:8768
    s_waitcnt lgkmcnt(4)
    v_mfma_f32_16x16x32_bf16 v[16:19], v[156:159], v[60:63], v[16:19]
    v_mfma_f32_16x16x32_bf16 v[20:23], v[188:191], v[60:63], v[20:23]
    ds_read_b128 v[56:59], v9 offset:8832
    s_waitcnt lgkmcnt(4)
    v_mfma_f32_16x16x32_bf16 v[16:19], v[160:163], v[40:43], v[16:19]
    v_mfma_f32_16x16x32_bf16 v[20:23], v[192:195], v[40:43], v[20:23]
    ds_read_b128 v[60:63], v9 offset:8896
    s_waitcnt lgkmcnt(4)
    v_mfma_f32_16x16x32_bf16 v[16:19], v[164:167], v[44:47], v[16:19]
    v_mfma_f32_16x16x32_bf16 v[20:23], v[196:199], v[44:47], v[20:23]
    ds_read_b128 v[40:43], v9 offset:8960
    s_waitcnt lgkmcnt(4)
    v_mfma_f32_16x16x32_bf16 v[24:27], v[136:139], v[48:51], 0
    v_mfma_f32_16x16x32_bf16 v[28:31], v[168:171], v[48:51], 0
    ds_read_b128 v[44:47], v9 offset:9024
    s_waitcnt lgkmcnt(4)
    v_mfma_f32_16x16x32_bf16 v[24:27], v[140:143], v[52:55], v[24:27]
    v_mfma_f32_16x16x32_bf16 v[28:31], v[172:175], v[52:55], v[28:31]
    ds_read_b128 v[48:51], v9 offset:9088
    s_waitcnt lgkmcnt(4)
    v_mfma_f32_16x16x32_bf16 v[24:27], v[144:147], v[56:59], v[24:27]
    v_mfma_f32_16x16x32_bf16 v[28:31], v[176:179], v[56:59], v[28:31]
    ds_read_b128 v[52:55], v9 offset:9152
    s_waitcnt vmcnt(0)
    s_waitcnt lgkmcnt(4)
    v_mfma_f32_16x16x32_bf16 v[24:27], v[148:151], v[60:63], v[24:27]
    v_mfma_f32_16x16x32_bf16 v[28:31], v[180:183], v[60:63], v[28:31]
    ds_read_b128 v[56:59], v9 offset:17408
    v_lshlrev_b32 v64, 16, v88
    v_and_b32 v65, s60, v88
    v_lshlrev_b32 v66, 16, v89
    v_and_b32 v67, s60, v89
    v_lshlrev_b32 v68, 16, v90
    v_and_b32 v69, s60, v90
    v_lshlrev_b32 v70, 16, v91
    v_and_b32 v71, s60, v91
    v_add_f32 v64, v64, v16
    v_add_f32 v65, v65, v17
    s_waitcnt lgkmcnt(4)
    v_mfma_f32_16x16x32_bf16 v[24:27], v[152:155], v[40:43], v[24:27]
    v_mfma_f32_16x16x32_bf16 v[28:31], v[184:187], v[40:43], v[28:31]
    ds_read_b128 v[60:63], v9 offset:17472
    v_add_f32 v66, v66, v18
    v_add_f32 v67, v67, v19
    v_add_f32 v68, v68, v20
    v_add_f32 v69, v69, v21
    v_add_f32 v70, v70, v22
    v_add_f32 v71, v71, v23
    v_exp_f32 v72, v64
    v_exp_f32 v73, v65
    v_exp_f32 v74, v66
    v_exp_f32 v75, v67
    s_waitcnt lgkmcnt(4)
    v_mfma_f32_16x16x32_bf16 v[24:27], v[156:159], v[44:47], v[24:27]
    v_mfma_f32_16x16x32_bf16 v[28:31], v[188:191], v[44:47], v[28:31]
    ds_read_b128 v[40:43], v9 offset:17536
    v_exp_f32 v76, v68
    v_exp_f32 v77, v69
    v_exp_f32 v78, v70
    v_exp_f32 v79, v71
    v_add_f32 v72, 1.0, v72
    v_add_f32 v73, 1.0, v73
    v_add_f32 v74, 1.0, v74
    v_add_f32 v75, 1.0, v75
    v_add_f32 v76, 1.0, v76
    v_add_f32 v77, 1.0, v77
    s_waitcnt lgkmcnt(4)
    v_mfma_f32_16x16x32_bf16 v[24:27], v[160:163], v[48:51], v[24:27]
    v_mfma_f32_16x16x32_bf16 v[28:31], v[192:195], v[48:51], v[28:31]
    ds_read_b128 v[44:47], v9 offset:17600
    v_add_f32 v78, 1.0, v78
    v_add_f32 v79, 1.0, v79
    v_rcp_f32 v72, v72
    v_rcp_f32 v73, v73
    v_rcp_f32 v74, v74
    v_rcp_f32 v75, v75
    v_rcp_f32 v76, v76
    v_rcp_f32 v77, v77
    v_rcp_f32 v78, v78
    v_rcp_f32 v79, v79
    s_waitcnt lgkmcnt(4)
    v_mfma_f32_16x16x32_bf16 v[24:27], v[164:167], v[52:55], v[24:27]
    v_mfma_f32_16x16x32_bf16 v[28:31], v[196:199], v[52:55], v[28:31]
    ds_read_b128 v[48:51], v9 offset:17664
    v_lshlrev_b32 v16, 16, v120
    v_and_b32 v17, s60, v120
    v_lshlrev_b32 v18, 16, v121
    v_and_b32 v19, s60, v121
    v_lshlrev_b32 v20, 16, v122
    v_and_b32 v21, s60, v122
    v_lshlrev_b32 v22, 16, v123
    v_and_b32 v23, s60, v123
    v_mul_f32 v64, v64, v72
    v_mul_f32 v65, v65, v73
    s_waitcnt lgkmcnt(4)
    v_mfma_f32_16x16x32_bf16 v[32:35], v[136:139], v[56:59], 0
    v_mfma_f32_16x16x32_bf16 v[36:39], v[168:171], v[56:59], 0
    ds_read_b128 v[52:55], v9 offset:17728
    v_mul_f32 v66, v66, v74
    v_mul_f32 v67, v67, v75
    s_waitcnt lgkmcnt(4)
    v_mfma_f32_16x16x32_bf16 v[32:35], v[140:143], v[60:63], v[32:35]
    v_mfma_f32_16x16x32_bf16 v[36:39], v[172:175], v[60:63], v[36:39]
    ds_read_b128 v[56:59], v9 offset:17792
    v_mul_f32 v68, v68, v76
    v_mul_f32 v69, v69, v77
    s_waitcnt lgkmcnt(4)
    v_mfma_f32_16x16x32_bf16 v[32:35], v[144:147], v[40:43], v[32:35]
    v_mfma_f32_16x16x32_bf16 v[36:39], v[176:179], v[40:43], v[36:39]
    ds_read_b128 v[60:63], v9 offset:17856
    v_mul_f32 v70, v70, v78
    v_mul_f32 v71, v71, v79
    v_fma_f32 v64, v64, s61, v16
    v_fma_f32 v65, v65, s61, v17
    v_fma_f32 v66, v66, s61, v18
    v_fma_f32 v67, v67, s61, v19
    v_fma_f32 v68, v68, s61, v20
    v_fma_f32 v69, v69, s61, v21
    v_fma_f32 v70, v70, s61, v22
    v_fma_f32 v71, v71, s61, v23
    v_cvt_pk_bf16_f32 v100, v64, v65
    v_cvt_pk_bf16_f32 v101, v66, v67
    v_cvt_pk_bf16_f32 v102, v68, v69
    v_cvt_pk_bf16_f32 v103, v70, v71
    s_add_u32 s58, s57, 0
    buffer_store_dwordx4 v[100:103], v6, s[40:43], s58 offen
    s_waitcnt lgkmcnt(4)
    v_mfma_f32_16x16x32_bf16 v[32:35], v[148:151], v[44:47], v[32:35]
    v_mfma_f32_16x16x32_bf16 v[36:39], v[180:183], v[44:47], v[36:39]
    v_lshlrev_b32 v64, 16, v92
    v_and_b32 v65, s60, v92
    v_lshlrev_b32 v66, 16, v93
    v_and_b32 v67, s60, v93
    v_lshlrev_b32 v68, 16, v94
    v_and_b32 v69, s60, v94
    v_lshlrev_b32 v70, 16, v95
    v_and_b32 v71, s60, v95
    v_add_f32 v64, v64, v24
    v_add_f32 v65, v65, v25
    s_waitcnt lgkmcnt(3)
    v_mfma_f32_16x16x32_bf16 v[32:35], v[152:155], v[48:51], v[32:35]
    v_mfma_f32_16x16x32_bf16 v[36:39], v[184:187], v[48:51], v[36:39]
    v_add_f32 v66, v66, v26
    v_add_f32 v67, v67, v27
    v_add_f32 v68, v68, v28
    v_add_f32 v69, v69, v29
    v_add_f32 v70, v70, v30
    v_add_f32 v71, v71, v31
    v_exp_f32 v72, v64
    v_exp_f32 v73, v65
    v_exp_f32 v74, v66
    v_exp_f32 v75, v67
    s_waitcnt lgkmcnt(2)
    v_mfma_f32_16x16x32_bf16 v[32:35], v[156:159], v[52:55], v[32:35]
    v_mfma_f32_16x16x32_bf16 v[36:39], v[188:191], v[52:55], v[36:39]
    v_exp_f32 v76, v68
    v_exp_f32 v77, v69
    v_exp_f32 v78, v70
    v_exp_f32 v79, v71
    v_add_f32 v72, 1.0, v72
    v_add_f32 v73, 1.0, v73
    v_add_f32 v74, 1.0, v74
    v_add_f32 v75, 1.0, v75
    v_add_f32 v76, 1.0, v76
    v_add_f32 v77, 1.0, v77
    s_waitcnt lgkmcnt(1)
    v_mfma_f32_16x16x32_bf16 v[32:35], v[160:163], v[56:59], v[32:35]
    v_mfma_f32_16x16x32_bf16 v[36:39], v[192:195], v[56:59], v[36:39]
    v_add_f32 v78, 1.0, v78
    v_add_f32 v79, 1.0, v79
    v_rcp_f32 v72, v72
    v_rcp_f32 v73, v73
    v_rcp_f32 v74, v74
    v_rcp_f32 v75, v75
    v_rcp_f32 v76, v76
    v_rcp_f32 v77, v77
    v_rcp_f32 v78, v78
    v_rcp_f32 v79, v79
    s_waitcnt lgkmcnt(0)
    v_mfma_f32_16x16x32_bf16 v[32:35], v[164:167], v[60:63], v[32:35]
    v_mfma_f32_16x16x32_bf16 v[36:39], v[196:199], v[60:63], v[36:39]
    v_lshlrev_b32 v24, 16, v124
    v_and_b32 v25, s60, v124
    v_lshlrev_b32 v26, 16, v125
    v_and_b32 v27, s60, v125
    v_lshlrev_b32 v28, 16, v126
    v_and_b32 v29, s60, v126
    v_lshlrev_b32 v30, 16, v127
    v_and_b32 v31, s60, v127
    v_mul_f32 v64, v64, v72
    v_mul_f32 v65, v65, v73
    v_mul_f32 v66, v66, v74
    v_mul_f32 v67, v67, v75
    v_mul_f32 v68, v68, v76
    v_mul_f32 v69, v69, v77
    v_mul_f32 v70, v70, v78
    v_mul_f32 v71, v71, v79
    v_fma_f32 v64, v64, s61, v24
    v_fma_f32 v65, v65, s61, v25
    v_fma_f32 v66, v66, s61, v26
    v_fma_f32 v67, v67, s61, v27
    v_fma_f32 v68, v68, s61, v28
    v_fma_f32 v69, v69, s61, v29
    v_fma_f32 v70, v70, s61, v30
    v_fma_f32 v71, v71, s61, v31
    v_cvt_pk_bf16_f32 v104, v64, v65
    v_cvt_pk_bf16_f32 v105, v66, v67
    v_cvt_pk_bf16_f32 v106, v68, v69
    v_cvt_pk_bf16_f32 v107, v70, v71
    s_add_u32 s58, s57, 8192
    buffer_store_dwordx4 v[104:107], v6, s[40:43], s58 offen
    s_nop 7
    v_mov_b32_dpp v32, v36 row_shr:8 row_mask:0xf bank_mask:0xc
    v_mov_b32_dpp v33, v37 row_shr:8 row_mask:0xf bank_mask:0xc
    v_mov_b32_dpp v34, v38 row_shr:8 row_mask:0xf bank_mask:0xc
    v_mov_b32_dpp v35, v39 row_shr:8 row_mask:0xf bank_mask:0xc
    v_lshlrev_b32 v64, 16, v96
    v_and_b32 v65, s60, v96
    v_lshlrev_b32 v66, 16, v97
    v_and_b32 v67, s60, v97
    v_add_f32 v64, v64, v32
    v_add_f32 v65, v65, v33
    v_add_f32 v66, v66, v34
    v_add_f32 v67, v67, v35
    v_exp_f32 v72, v64
    v_exp_f32 v73, v65
    v_exp_f32 v74, v66
    v_exp_f32 v75, v67
    v_add_f32 v72, 1.0, v72
    v_add_f32 v73, 1.0, v73
    v_add_f32 v74, 1.0, v74
    v_add_f32 v75, 1.0, v75
    v_rcp_f32 v72, v72
    v_rcp_f32 v73, v73
    v_rcp_f32 v74, v74
    v_rcp_f32 v75, v75
    v_lshlrev_b32 v32, 16, v128
    v_and_b32 v33, s60, v128
    v_lshlrev_b32 v34, 16, v129
    v_and_b32 v35, s60, v129
    v_mul_f32 v64, v64, v72
    v_mul_f32 v65, v65, v73
    v_mul_f32 v66, v66, v74
    v_mul_f32 v67, v67, v75
    v_fma_f32 v64, v64, s61, v32
    v_fma_f32 v65, v65, s61, v33
    v_fma_f32 v66, v66, s61, v34
    v_fma_f32 v67, v67, s61, v35
    v_cvt_pk_bf16_f32 v108, v64, v65
    v_cvt_pk_bf16_f32 v109, v66, v67
    s_add_u32 s58, s57, 16384
    buffer_store_dwordx2 v[108:109], v10, s[40:43], s58 offen
    s_mov_b64 exec, -1
    s_cmp_lg_u32 s3, 0
    s_cbranch_scc1 L2_done
    s_mov_b32 exec_hi, 0x0fffffff
    v_lshlrev_b32 v10, 1, v1
    v_mul_u32_u24 v11, 171, v10
    v_lshrrev_b32 v11, 9, v11
    v_mul_u32_u24 v12, 3, v11
    v_sub_u32 v12, v10, v12
    v_lshrrev_b32 v13, 3, v11
    v_lshlrev_b32 v13, 5, v13
    v_lshl_add_u32 v13, v12, 3, v13
    v_and_b32 v11, 7, v11
    v_add3_u32 v13, v13, v11, 8
    v_lshlrev_b32 v13, 2, v13
    v_add_u32 v13, 160512, v13
    ds_read_b32 v14, v13
    v_lshlrev_b32 v10, 1, v1
    v_add_u32 v10, 1, v10
    v_mul_u32_u24 v11, 171, v10
    v_lshrrev_b32 v11, 9, v11
    v_mul_u32_u24 v12, 3, v11
    v_sub_u32 v12, v10, v12
    v_lshrrev_b32 v13, 3, v11
    v_lshlrev_b32 v13, 5, v13
    v_lshl_add_u32 v13, v12, 3, v13
    v_and_b32 v11, 7, v11
    v_add3_u32 v13, v13, v11, 8
    v_lshlrev_b32 v13, 2, v13
    v_add_u32 v13, 160512, v13
    ds_read_b32 v15, v13
    v_lshlrev_b32 v10, 16, v8
    v_and_b32 v11, s60, v8
    s_waitcnt lgkmcnt(0)
    v_fma_f32 v10, v14, s61, v10
    v_fma_f32 v11, v15, s61, v11
    v_cvt_pk_bf16_f32 v10, v10, v11
    buffer_store_dword v10, v7, s[48:51], s59 offen
L2_done:
L_exit:
    s_endpgm
.section .rodata,"a"
.p2align 6
.amdhsa_kernel standalone__cheap_equivariant_egnn__graph_kernel
  .amdhsa_next_free_vgpr 249
  .amdhsa_next_free_sgpr 88
  .amdhsa_accum_offset 252
  .amdhsa_group_segment_fixed_size 0
  .amdhsa_kernarg_size 88
  .amdhsa_user_sgpr_count 2
  .amdhsa_user_sgpr_kernarg_segment_ptr 1
  .amdhsa_system_sgpr_workgroup_id_x 1
  .amdhsa_float_denorm_mode_32 3
.end_amdhsa_kernel
```
